```python
import torch

def _softmax(x, axis=-1):
    return torch.softmax(x, dim=axis)
def _gelu(x):
    return torch.nn.functional.gelu(x, approximate="tanh")
def _silu(x):
    return torch.nn.functional.silu(x)
def _sigmoid(x):
    return torch.sigmoid(x)
def _layernorm(x, axis=-1, eps=1e-5):
    m = x.mean(dim=axis, keepdim=True)
    v = x.var(dim=axis, keepdim=True, unbiased=False)
    return (x - m) / torch.sqrt(v + eps)
def _scatter_add(tgt, idx, src, axis=0):
    return tgt.clone().index_add_(axis, idx, src)
def _segment_sum(src, seg, n):
    out = torch.zeros((n,) + src.shape[1:], dtype=src.dtype)
    return out.index_add_(0, seg, src)
def _pad(x, pw):
    flat = tuple(v for pair in reversed(pw) for v in pair)
    return torch.nn.functional.pad(x, flat)

kernel_name = 'sequential_preLN__linear_attn_block__dense_activation_gelu__prompt'

def setup_inputs():

    _w = (lambda a: (lambda t: t.to(torch.bfloat16) if t.is_floating_point() else t)(torch.as_tensor(a)))
    def _A_setup():
        B, S, D = 1, 2048, 512
        return {
            "x": _w((lambda *s: torch.randn(*s, dtype=torch.bfloat16) * 0.05)(B, S, D)),
            "wqkv": _w((lambda *s: torch.randn(*s, dtype=torch.bfloat16) * 0.05)(D, 3 * D)),
            "wo": _w((lambda *s: torch.randn(*s, dtype=torch.bfloat16) * 0.05)(D, D)),
        }
    _A_in = _A_setup()

    def _B_setup():
        B, S, D, F = 1, 2048, 512, 1376
        return {
            "x": _w((lambda *s: torch.randn(*s, dtype=torch.bfloat16) * 0.05)(B, S, D)),
            "w1": _w((lambda *s: torch.randn(*s, dtype=torch.bfloat16) * 0.8)(D, F) * (D ** -0.5)),
            "b1": _w((lambda *s: torch.randn(*s, dtype=torch.bfloat16) * 12.8)(F) * 0.01),
            "w2": _w((lambda *s: torch.randn(*s, dtype=torch.bfloat16) * 0.2)(F, D) * (F ** -0.5)),
            "b2": _w((lambda *s: torch.randn(*s, dtype=torch.bfloat16) * 3.2)(D) * 0.01),
        }
    _B_in = _B_setup()

    return {
        "A_x": _A_in["x"],
        "A_wqkv": _A_in["wqkv"],
        "A_wo": _A_in["wo"],
        "B_x": _B_in["x"],
        "B_w1": _B_in["w1"],
        "B_b1": _B_in["b1"],
        "B_w2": _B_in["w2"],
        "B_b2": _B_in["b2"],
    }

def reference(A_x, A_wqkv, A_wo, B_x, B_w1, B_b1, B_w2, B_b2):
    def _A_ref(x, wqkv, wo):
        B, S, D = x.shape
        H = 32; Dh = D // H
        qkv = (lambda x, *d: x.permute(*d))((x @ wqkv).reshape(B, S, 3, H, Dh), 2, 0, 3, 1, 4)
        q, k, v = qkv[0], qkv[1], qkv[2]
        phi = lambda t: torch.where(t > 0, t + 1, torch.exp(t)) + 1e-6
        pq, pk = phi(q), phi(k)
        kv = torch.einsum("bhsd,bhse->bhde", pk, v)
        z = torch.einsum("bhsd->bhd", pk)
        num = torch.einsum("bhqd,bhde->bhqe", pq, kv)
        den = torch.einsum("bhqd,bhd->bhq", pq, z)[..., None] + 1e-6
        o = num / den
        return (lambda x, *d: x.permute(*d))(o, 0, 2, 1, 3).reshape(B, S, D) @ wo

    def _B_ref(x, w1, b1, w2, b2):
        h = torch.einsum("bsd,df->bsf", x, w1) + b1
        h = _gelu(h)
        return torch.einsum("bsf,fd->bsd", h, w2) + b2

    x = A_x
    h = x + _A_ref(_layernorm(x, axis=-1), A_wqkv, A_wo)
    h2 = h + _B_ref(_layernorm(h, axis=-1), B_w1, B_b1, B_w2, B_b2)
    return h2
```

```asm
; @launch grid=(256,1,1) block=(256,1,1) lds=163840
.amdgcn_target "amdgcn-amd-amdhsa--gfx950"
.text
.globl sequential_preLN__linear_attn_block__dense_activation_gelu__prompt_kernel
.p2align 12
.fill 832, 4, 0xbf800000
.p2align 8
.type sequential_preLN__linear_attn_block__dense_activation_gelu__prompt_kernel,@function
sequential_preLN__linear_attn_block__dense_activation_gelu__prompt_kernel:
  s_load_dwordx2 s[4:5], s[0:1], 0
  s_load_dwordx2 s[8:9], s[0:1], 8
  s_load_dwordx2 s[12:13], s[0:1], 16
  s_load_dwordx2 s[16:17], s[0:1], 32
  s_load_dwordx2 s[24:25], s[0:1], 48
  v_lshrrev_b32 v49, 6, v0
  s_lshr_b32 s49, s2, 6
  s_cmp_ge_u32 s49, 4
  s_cbranch_scc1 L_end
  v_readfirstlane_b32 s46, v49
  v_bfe_u32 v48, v0, 3, 3
  v_bfe_u32 v3, v0, 4, 2
  v_and_b32 v50, 7, v0
  v_and_b32 v1, 63, v0
  s_and_b32 s43, s2, 7
  s_lshr_b32 s50, s2, 3
  s_and_b32 s44, s50, 7
  s_lshl2_add_u32 s45, s43, s49
  s_lshl2_add_u32 s74, s50, s46
  v_lshlrev_b32 v15, 7, v1
  s_getpc_b64 s[58:59]
L_pc:
  s_lshl_b32 s50, s74, 9
  s_min_u32 s50, s50, L_code_end-L_pc-388
  v_add_u32 v14, s50, v15
  s_mov_b64 exec, 15
  global_load_dword v255, v14, s[58:59]
  s_mov_b64 exec, -1
  s_lshl_b32 s53, s45, 16
  s_lshl_b32 s68, s46, 11
  s_mov_b32 s7, 0x20000
  s_lshl_b32 s6, s7, 4
  v_lshl_add_u32 v49, v49, 4, v48
  v_xor_b32 v51, v3, v50
  v_lshl_add_u32 v51, v51, 4, s53
  s_add_u32 s57, s43, s44
  s_and_b32 s56, s57, 7
  s_lshl_b32 s57, s56, 7
  v_lshl_add_u32 v24, v49, 10, v51
  v_xor_b32 v25, 64, v24
  v_add_u32 v25, 7168, v25
  v_lshrrev_b32 v49, 3, v0
  v_and_b32 v51, 2, v49
  v_lshrrev_b32 v14, 1, v49
  s_mov_b32 s11, s7
  s_mul_i32 s10, s7, 12
  s_lshl_b32 s51, s44, 7
  v_and_or_b32 v51, v14, 4, v51
  v_xor_b32 v51, v51, v50
  s_lshl_b32 s54, s46, 10
  s_and_b32 s71, s49, 1
  s_mul_i32 s73, s71, 98304
  s_add_u32 s51, s51, s73
  v_lshl_add_u32 v51, v51, 4, s51
  v_mul_u32_u24 v49, 3072, v49
  v_add_u32 v26, v49, v51
  s_mul_i32 s81, s56, 196608
  s_mul_i32 s56, s56, 0x11111111
  s_add_u32 s56, s56, 0x76543210
  s_and_b32 s56, s56, 0x77777777
  s_mov_b32 s15, s7
  s_mov_b32 s19, s7
  s_mov_b32 s27, s7
  s_lshl_b32 s14, s7, 2
  s_mov_b32 s18, 1409024
  s_mov_b32 s26, s18
  s_lshl2_add_u32 s52, s2, s46
  s_lshl_b32 s51, s52, 9
  s_mul_i32 s52, s52, 1408
  s_lshr_b32 s48, s46, 1
  s_mul_i32 s69, s46, 3072
  s_and_b32 s47, s46, 1
  s_lshl_b32 s70, s46, 14
  s_mul_i32 s40, s45, 393216
  s_add_u32 s40, s40, 2097152
  s_lshl2_add_u32 s41, s44, s40
  v_lshlrev_b32 v2, 4, v1
  v_and_b32 v7, 15, v1
  v_bfe_u32 v4, v1, 2, 2
  v_and_b32 v5, 3, v1
  v_lshrrev_b32 v6, 5, v1
  v_lshrrev_b32 v51, 1, v7
  v_xor_b32 v51, v51, v3
  v_lshlrev_b32 v51, 4, v51
  s_lshl_b32 s51, s71, 6
  s_add_u32 s51, s51, 65536
  v_xor_b32 v51, s51, v51
  v_lshl_add_u32 v232, v7, 7, v51
  v_xor_b32 v233, 64, v232
  v_add_u32 v236, s68, v232
  v_add_u32 v237, s68, v233
  v_and_b32 v51, 1, v3
  v_lshrrev_b32 v49, 1, v4
  v_lshl_or_b32 v51, v51, 1, v49
  v_xor_b32 v51, s46, v51
  v_lshlrev_b32 v51, 5, v51
  v_lshl_add_u32 v51, v5, 3, v51
  v_lshl_add_u32 v51, v4, 7, v51
  v_lshl_add_u32 v234, v3, 11, v51
  v_add_u32 v235, 131072, v234
  v_lshl_add_u32 v52, v3, 10, v51
  v_add_u32 v53, 155648, v52
  v_mov_b32 v8, 0x3f803f80
  v_mov_b32 v9, 0x3f803f80
  v_mov_b32 v10, 0x3f803f80
  v_mov_b32 v11, 0x3f803f80
  v_lshlrev_b32 v240, 2, v7
  v_add_u32 v240, 160768, v240
  s_lshl_b32 s51, s46, 6
  v_add_u32 v238, s51, v240
  v_lshlrev_b32 v239, 4, v3
  v_add_u32 v239, 160768, v239
  v_and_b32 v51, 2, v48
  v_lshlrev_b32 v51, 1, v51
  v_xor_b32 v51, v51, v50
  s_lshl_b32 s51, s44, 7
  s_add_u32 s51, s51, s70
  v_lshl_add_u32 v30, v51, 4, s51
  v_lshl_add_u32 v30, v48, 10, v30
  v_add_u32 v31, 7168, v30
  v_and_b32 v49, 1, v48
  v_lshlrev_b32 v49, 2, v49
  v_sub_u32 v51, v51, v49
  s_mov_b32 s49, s44
  s_add_u32 s50, s49, 1
  s_and_b32 s50, s50, 8
  s_lshl_b32 s50, s50, 27
  s_mul_i32 s51, s49, 384
  s_mul_i32 s52, s46, 22016
  s_add_u32 s51, s51, s52
  s_add_u32 s51, s51, 2048
  v_mul_u32_u24 v49, 2752, v48
  v_add_u32 v49, s51, v49
  v_lshl_add_u32 v49, v51, 4, v49
  v_lshlrev_b32 v14, 28, v51
  v_ashrrev_i32 v51, 31, v51
  v_and_b32 v51, 384, v51
  v_add_u32 v27, v49, v51
  v_and_or_b32 v27, v14, s50, v27
  v_add_u32 v49, s50, v49
  v_subrev_u32 v28, 896, v49
  v_subrev_u32 v29, 1792, v49
  s_add_u32 m0, s68, 65536
  s_waitcnt lgkmcnt(0)
  buffer_load_dwordx4 v24, s[4:7], s57 offen lds
  buffer_load_dwordx4 v25, s[4:7], s57 offen offset:1024 lds
  s_add_u32 m0, s68, 48128
  s_nop 0
  buffer_load_dwordx4 v26, s[8:11], s81 offen offset:1024 lds
  buffer_load_dwordx4 v26, s[8:11], s81 offen offset:2048 lds
  s_add_u32 m0, s54, 155648
  s_nop 0
  buffer_load_dwordx4 v26, s[8:11], s81 offen lds
  s_load_dwordx2 s[36:37], s[0:1], 80
  s_load_dwordx2 s[20:21], s[0:1], 40
  s_load_dwordx2 s[28:29], s[0:1], 56
  s_load_dwordx2 s[32:33], s[0:1], 64
  v_lshlrev_b32 v15, 10, v1
  s_lshl_b32 s73, s73, 1
  s_sub_u32 s73, 98304, s73
  v_add_u32 v243, s73, v26
  s_mov_b64 exec, 0xfff
  s_mul_i32 s52, s74, 12288
  buffer_load_dword v255, v15, s[8:11], s52 offen offset:384
  s_mov_b64 exec, -1
  s_sub_u32 s16, s16, 2048
  s_subb_u32 s17, s17, 0
  s_add_u32 s18, s18, 2048
  s_add_u32 s57, s57, 128
  s_and_b32 s57, s57, 0x380
  s_add_u32 m0, s68, 73728
  s_nop 0
  buffer_load_dwordx4 v24, s[4:7], s57 offen lds
  buffer_load_dwordx4 v25, s[4:7], s57 offen offset:1024 lds
  s_add_u32 m0, s68, 56320
  s_nop 0
  buffer_load_dwordx4 v243, s[8:11], s81 offen offset:1024 lds
  buffer_load_dwordx4 v243, s[8:11], s81 offen offset:2048 lds
  s_mov_b64 exec, 0
  s_cmp_eq_u32 s46, 0
  s_cbranch_scc1 L_pad1
  s_cmp_eq_u32 s46, 1
  s_cbranch_scc1 L_pad2
  s_cmp_eq_u32 s46, 2
  s_cbranch_scc1 L_pad3
  s_branch L_padw
L_touch:
  s_lshl2_add_u32 s52, s2, s46
  s_lshl_b32 s51, s52, 9
  s_mul_i32 s52, s52, 1408
  s_mov_b64 exec, 15
  buffer_load_dword v255, v0, s[12:15], s51 offen
  s_mov_b64 exec, 0x7ff
  buffer_load_dword v255, v0, s[16:19], s52 offen offset:2048
  s_mov_b64 exec, -1
  s_lshl2_add_u32 s51, s44, s46
  s_lshl_b32 s51, s51, 8
  s_add_u32 s51, s51, s40
  s_mov_b64 exec, 3
  buffer_load_dword v255, v0, s[36:39], s51 offen sc1
  s_lshl_b32 s51, s2, 7
  s_lshl_b32 s52, s47, 15
  s_add_u32 s51, s51, s52
  s_add_u32 s51, s51, 32768
  buffer_load_dword v255, off, s[36:39], s51 sc1
  buffer_load_dword v255, off, s[32:35], s53
  s_mov_b64 exec, -1
  s_lshl_b32 s51, s46, 6
  s_lshl_b32 s52, s48, 6
  buffer_load_ushort v248, v241, s[20:23], s51 offen offset:128
  buffer_load_ushort v249, v241, s[20:23], s52 offen
  buffer_load_dwordx2 v[250:251], v242, s[28:31], 0 offen offset:0
  buffer_load_dwordx2 v[252:253], v242, s[28:31], 0 offen offset:16
  s_cmp_eq_u32 s3, 0
  s_cbranch_scc1 L_tb0
  s_cmp_eq_u32 s3, 1
  s_cbranch_scc1 L_tb1
  s_cmp_eq_u32 s3, 2
  s_cbranch_scc1 L_tb2
  s_cmp_eq_u32 s3, 3
  s_cbranch_scc1 L_tb3
  s_cmp_eq_u32 s3, 4
  s_cbranch_scc1 L_tb4
  s_cmp_eq_u32 s3, 5
  s_cbranch_scc1 L_tb5
  s_cmp_eq_u32 s3, 6
  s_cbranch_scc1 L_tb6
  s_branch L_tb7
L_padback:
  s_mov_b64 exec, -1
  s_mov_b32 s38, 16777216
  s_mov_b32 s39, 0x20000
  s_mov_b32 s22, 2752
  s_mov_b32 s23, 0x20000
  s_mov_b32 s30, 1024
  s_mov_b32 s31, 0x20000
  s_mov_b32 s34, 2097152
  s_mov_b32 s35, 0x20000
  s_waitcnt lgkmcnt(0)
  s_load_dword s42, s[36:37], 0
  s_lshl_b32 s51, s46, 8
  v_lshl_add_u32 v13, v7, 6, s51
  s_lshl_b32 s51, s44, 9
  s_add_u32 s51, s51, 0x2000
  s_lshl_b32 s52, s46, 7
  v_cmp_gt_u32 vcc, 2, v1
  v_lshl_add_u32 v49, v1, 2, s51
  v_add_u32 v51, s52, v49
  v_cndmask_b32 v246, v51, v49, vcc
  v_and_b32 v51, 31, v1
  s_mul_i32 s51, s49, 384
  v_lshl_add_u32 v241, v51, 1, s51
  s_lshl_b32 s51, s44, 7
  s_lshl_b32 s52, s46, 5
  s_add_u32 s51, s51, s52
  v_lshl_add_u32 v242, v6, 3, s51
  v_lshlrev_b32 v0, 7, v7
  s_mov_b32 s64, 0x358637bd
  s_mov_b32 s65, 0x358637bd
  s_mov_b32 s66, 0x3fb8aa3b
  s_mov_b32 s67, 0x3fb8aa3b
  s_mov_b32 s58, 0x22222222
  s_mov_b32 s59, 0x22222222
  s_mov_b32 s60, 0x44444444
  s_mov_b32 s61, 0x44444444
  s_mov_b32 s62, 0x88888888
  s_mov_b32 s63, 0x88888888
  s_mov_b32 s75, 0x0c0c0400
  s_mov_b32 s76, 0x04000c0c
  s_mov_b32 s77, 0x05040100
  s_mov_b32 s78, 0x07060302
  s_mov_b32 s79, 0xffffff00
  s_mov_b32 s80, 0xffff0000
  v_and_b32 v48, 2, v4
  v_and_or_b32 v48, v3, 1, v48
  v_lshlrev_b32 v48, 5, v48
  v_lshl_add_u32 v48, v5, 3, v48
  v_lshl_add_u32 v48, v4, 7, v48
  v_lshl_add_u32 v47, v6, 9, v48
  s_mul_i32 s51, s48, 4160
  s_add_u32 s51, s51, 65536
  v_xor_b32 v42, s51, v47
  v_xor_b32 v43, 64, v42
  v_and_b32 v49, 1, v4
  s_add_u32 s51, s46, 2
  v_add_u32 v50, s51, v49
  v_subrev_u32 v51, 6, v50
  v_min_u32 v50, v50, v51
  v_and_b32 v51, 1, v50
  v_lshlrev_b32 v51, 6, v51
  v_xor_b32 v51, v51, v47
  v_lshrrev_b32 v50, 1, v50
  v_lshl_add_u32 v32, v50, 10, v51
  v_add_u32 v34, 65536, v32
  v_add_u32 v36, 131072, v32
  v_add_u32 v50, s48, v49
  v_and_b32 v51, 1, v50
  v_lshlrev_b32 v51, 6, v51
  v_xor_b32 v51, v51, v47
  v_lshrrev_b32 v50, 1, v50
  v_lshl_add_u32 v33, v50, 10, v51
  v_add_u32 v35, 65536, v33
  v_add_u32 v37, 131072, v33
  s_lshl1_add_u32 s51, s46, s44
  s_lshl_b32 s51, s51, 8
  v_and_b32 v40, 0x1f0, v2
  v_add_u32 v40, s51, v40
  v_and_b32 v40, 0x7ff, v40
  s_mul_i32 s51, s46, 4352
  s_add_u32 s51, s51, 131072
  v_lshlrev_b32 v48, 4, v7
  v_lshl_add_u32 v48, v6, 8, v48
  v_and_b32 v49, 1, v3
  v_lshl_add_u32 v50, v49, 3, v48
  v_add_u32 v38, s51, v50
  v_lshrrev_b32 v50, 2, v48
  v_lshl_add_u32 v46, v49, 11, v50
  v_bfe_u32 v50, v1, 2, 3
  v_mul_u32_u24 v50, 544, v50
  v_lshl_add_u32 v50, v5, 3, v50
  v_add_u32 v39, s51, v50
  v_lshlrev_b32 v50, 4, v6
  v_add_u32 v50, 512, v50
  v_cmp_eq_u32 vcc, 0, v49
  s_mul_i32 s51, s48, 1088
  s_add_u32 s51, s51, 131072
  v_cndmask_b32 v48, v48, v50, vcc
  v_add_u32 v41, s51, v48
  s_xor_b32 s51, s46, 0
  s_lshl_b32 s52, s51, 12
  s_add_u32 s52, s52, 144384
  s_cmp_eq_u32 s51, 0
  s_cselect_b32 s52, 61440, s52
  v_add_u32 v44, s52, v2
  s_xor_b32 s51, s46, 2
  s_lshl_b32 s52, s51, 12
  s_add_u32 s52, s52, 144384
  s_cmp_eq_u32 s51, 0
  s_cselect_b32 s52, 61440, s52
  v_add_u32 v45, s52, v2
  v_lshrrev_b32 v228, 2, v1
  v_and_b32 v229, 0x30, v2
  v_lshl_add_u32 v228, v228, 11, v229
  v_and_b32 v229, 0x30, v1
  s_add_u32 s57, s57, 128
  s_and_b32 s57, s57, 0x380
  s_add_u32 m0, s68, 81920
  s_nop 0
  buffer_load_dwordx4 v24, s[4:7], s57 offen lds
  buffer_load_dwordx4 v25, s[4:7], s57 offen offset:1024 lds
  s_bfe_u32 s81, s56, 0x40004
  s_mul_i32 s81, s81, 196608
  s_add_u32 m0, s68, 130048
  s_nop 0
  buffer_load_dwordx4 v26, s[8:11], s81 offen offset:1024 lds
  buffer_load_dwordx4 v26, s[8:11], s81 offen offset:2048 lds
  s_add_u32 s57, s57, 128
  s_and_b32 s57, s57, 0x380
  s_add_u32 m0, s68, 90112
  s_nop 0
  buffer_load_dwordx4 v24, s[4:7], s57 offen lds
  buffer_load_dwordx4 v25, s[4:7], s57 offen offset:1024 lds
  s_waitcnt lgkmcnt(0)
  s_mul_i32 s42, s42, 0x19660d
  s_add_u32 s42, s42, 0x3c6ef35f
  v_mov_b32 v12, s42
  s_getreg_b32 s0, hwreg(HW_REG_XCC_ID, 0, 4)
  s_lshl_b32 s0, s0, 4
  s_xor_b32 s0, s0, s42
  s_mov_b32 s1, s0
  v_mov_b32 v244, s0
  s_waitcnt vmcnt(12)
  s_barrier
  s_and_b32 s3, s45, 3
  s_and_b32 s51, s44, 1
  s_lshl2_add_u32 s3, s51, s3
  ds_read_b64_tr_b16 v[116:117], v234 offset:49152
  ds_read_b64_tr_b16 v[118:119], v234 offset:49664
  ds_read_b64_tr_b16 v[120:121], v234 offset:50176
  ds_read_b64_tr_b16 v[122:123], v234 offset:50688
  ds_read_b128 v[132:135], v236 offset:0
  ds_read_b128 v[136:139], v237 offset:0
  ds_read_b128 a[0:3], v232 offset:0
  ds_read_b128 a[4:7], v232 offset:2048
  ds_read_b128 a[8:11], v232 offset:4096
  ds_read_b128 a[12:15], v232 offset:6144
  s_waitcnt lgkmcnt(8)
  v_mfma_f32_16x16x32_bf16 v[88:91], v[8:11], v[116:119], 0
  s_add_u32 m0, s68, 138240
  s_nop 0
  buffer_load_dwordx4 v243, s[8:11], s81 offen offset:1024 lds
  s_waitcnt lgkmcnt(6)
  v_mfma_f32_16x16x32_bf16 v[108:111], v[8:11], v[120:123], 0
  buffer_load_dwordx4 v243, s[8:11], s81 offen offset:2048 lds
  s_bfe_u32 s81, s56, 0x40008
  s_waitcnt lgkmcnt(5)
  v_mfma_f32_16x16x32_bf16 v[148:151], v[8:11], v[132:135], 0
  s_mul_i32 s81, s81, 196608
  s_add_u32 m0, s68, 146432
  ds_read_b128 a[16:19], v233 offset:0
  v_mfma_f32_16x16x32_bf16 v[152:155], v[132:135], v[132:135], 0
  buffer_load_dwordx4 v26, s[8:11], s81 offen offset:1024 lds
  ds_read_b128 a[20:23], v233 offset:2048
  s_waitcnt lgkmcnt(6)
  v_mfma_f32_16x16x32_bf16 v[148:151], v[8:11], v[136:139], v[148:151]
  buffer_load_dwordx4 v26, s[8:11], s81 offen offset:2048 lds
  s_add_u32 s57, s57, 128
  v_mfma_f32_16x16x32_bf16 v[152:155], v[136:139], v[136:139], v[152:155]
  s_and_b32 s57, s57, 0x380
  s_add_u32 m0, s68, 98304
  ds_read_b128 a[24:27], v233 offset:4096
  s_waitcnt lgkmcnt(6)
  v_mfma_f32_16x16x32_bf16 v[56:59], a[0:3], v[116:119], 0
  buffer_load_dwordx4 v24, s[4:7], s57 offen lds
  buffer_load_dwordx4 v25, s[4:7], s57 offen offset:1024 lds
  ds_read_b128 a[28:31], v233 offset:6144
  s_waitcnt lgkmcnt(6)
  v_mfma_f32_16x16x32_bf16 v[60:63], a[4:7], v[116:119], 0
  s_cmp_eq_u32 s3, 0
  s_cbranch_scc1 L_touch
L_tb0:
  s_waitcnt vmcnt(12)
  s_barrier
  s_waitcnt lgkmcnt(5)
  v_mfma_f32_16x16x32_bf16 v[64:67], a[8:11], v[116:119], 0
  ds_read_b64_tr_b16 v[124:125], v234 offset:57344
  ds_read_b64_tr_b16 v[126:127], v234 offset:57856
  s_waitcnt lgkmcnt(6)
  v_mfma_f32_16x16x32_bf16 v[68:71], a[12:15], v[116:119], 0
  s_mov_b32 m0, s68
  ds_read_b64_tr_b16 v[128:129], v234 offset:58368
  ds_read_b64_tr_b16 v[130:131], v234 offset:58880
  v_mfma_f32_16x16x32_bf16 v[72:75], a[0:3], v[120:123], 0
  s_add_u32 s72, s81, 1024
  ds_read_b128 v[132:135], v236 offset:8192
  ds_read_b128 v[136:139], v237 offset:8192
  v_mfma_f32_16x16x32_bf16 v[76:79], a[4:7], v[120:123], 0
  buffer_load_dwordx4 v243, s[8:11], s72 offen offset:0 lds
  ds_read_b128 a[32:35], v232 offset:8192
  v_mfma_f32_16x16x32_bf16 v[80:83], a[8:11], v[120:123], 0
  v_mfma_f32_16x16x32_bf16 v[84:87], a[12:15], v[120:123], 0
  buffer_load_dwordx4 v243, s[8:11], s72 offen offset:1024 lds
  ds_read_b128 a[36:39], v232 offset:10240
  s_waitcnt lgkmcnt(6)
  v_mfma_f32_16x16x32_bf16 v[88:91], v[8:11], v[124:127], v[88:91]
  s_bfe_u32 s81, s56, 0x4000c
  s_waitcnt lgkmcnt(4)
  v_mfma_f32_16x16x32_bf16 v[108:111], v[8:11], v[128:131], v[108:111]
  s_waitcnt lgkmcnt(3)
  v_mfma_f32_16x16x32_bf16 v[148:151], v[8:11], v[132:135], v[148:151]
  s_mul_i32 s81, s81, 196608
  ds_read_b128 a[40:43], v232 offset:12288
  v_mfma_f32_16x16x32_bf16 v[152:155], v[132:135], v[132:135], v[152:155]
  s_add_u32 m0, s68, 7168
  s_waitcnt lgkmcnt(3)
  v_mfma_f32_16x16x32_bf16 v[148:151], v[8:11], v[136:139], v[148:151]
  v_mfma_f32_16x16x32_bf16 v[152:155], v[136:139], v[136:139], v[152:155]
  buffer_load_dwordx4 v26, s[8:11], s81 offen offset:1024 lds
  ds_read_b128 a[44:47], v232 offset:14336
  v_mfma_f32_16x16x32_bf16 v[56:59], a[16:19], v[124:127], v[56:59]
  buffer_load_dwordx4 v26, s[8:11], s81 offen offset:2048 lds
  v_mfma_f32_16x16x32_bf16 v[60:63], a[20:23], v[124:127], v[60:63]
  s_waitcnt vmcnt(12)
  s_barrier
  v_mfma_f32_16x16x32_bf16 v[64:67], a[24:27], v[124:127], v[64:67]
  ds_read_b64_tr_b16 v[116:117], v235 offset:0
  ds_read_b64_tr_b16 v[118:119], v235 offset:512
  v_mfma_f32_16x16x32_bf16 v[68:71], a[28:31], v[124:127], v[68:71]
  s_add_u32 s57, s57, 128
  ds_read_b64_tr_b16 v[120:121], v235 offset:1024
  ds_read_b64_tr_b16 v[122:123], v235 offset:1536
  v_mfma_f32_16x16x32_bf16 v[72:75], a[16:19], v[128:131], v[72:75]
  s_and_b32 s57, s57, 0x380
  ds_read_b128 v[132:135], v236 offset:16384
  ds_read_b128 v[136:139], v237 offset:16384
  v_mfma_f32_16x16x32_bf16 v[76:79], a[20:23], v[128:131], v[76:79]
  s_add_u32 m0, s68, 106496
  ds_read_b128 a[48:51], v233 offset:8192
  v_mfma_f32_16x16x32_bf16 v[80:83], a[24:27], v[128:131], v[80:83]
  v_mfma_f32_16x16x32_bf16 v[84:87], a[28:31], v[128:131], v[84:87]
  buffer_load_dwordx4 v24, s[4:7], s57 offen lds
  ds_read_b128 a[52:55], v233 offset:10240
  s_waitcnt lgkmcnt(6)
  v_mfma_f32_16x16x32_bf16 v[88:91], v[8:11], v[116:119], v[88:91]
  buffer_load_dwordx4 v25, s[4:7], s57 offen offset:1024 lds
  s_waitcnt lgkmcnt(4)
  v_mfma_f32_16x16x32_bf16 v[108:111], v[8:11], v[120:123], v[108:111]
  s_waitcnt lgkmcnt(3)
  v_mfma_f32_16x16x32_bf16 v[148:151], v[8:11], v[132:135], v[148:151]
  s_add_u32 m0, s68, 15360
  ds_read_b128 a[56:59], v233 offset:12288
  v_mfma_f32_16x16x32_bf16 v[152:155], v[132:135], v[132:135], v[152:155]
  buffer_load_dwordx4 v243, s[8:11], s81 offen offset:1024 lds
  s_waitcnt lgkmcnt(3)
  v_mfma_f32_16x16x32_bf16 v[148:151], v[8:11], v[136:139], v[148:151]
  v_mfma_f32_16x16x32_bf16 v[152:155], v[136:139], v[136:139], v[152:155]
  buffer_load_dwordx4 v243, s[8:11], s81 offen offset:2048 lds
  ds_read_b128 a[60:63], v233 offset:14336
  v_mfma_f32_16x16x32_bf16 v[56:59], a[32:35], v[116:119], v[56:59]
  s_cmp_eq_u32 s3, 1
  s_cbranch_scc1 L_touch
L_tb1:
  v_mfma_f32_16x16x32_bf16 v[60:63], a[36:39], v[116:119], v[60:63]
  s_waitcnt vmcnt(10)
  s_barrier
  v_mfma_f32_16x16x32_bf16 v[64:67], a[40:43], v[116:119], v[64:67]
  ds_read_b64_tr_b16 v[124:125], v235 offset:8192
  ds_read_b64_tr_b16 v[126:127], v235 offset:8704
  v_mfma_f32_16x16x32_bf16 v[68:71], a[44:47], v[116:119], v[68:71]
  s_bfe_u32 s81, s56, 0x40010
  ds_read_b64_tr_b16 v[128:129], v235 offset:9216
  ds_read_b64_tr_b16 v[130:131], v235 offset:9728
  v_mfma_f32_16x16x32_bf16 v[72:75], a[32:35], v[120:123], v[72:75]
  ds_read_b128 v[132:135], v236 offset:24576
  ds_read_b128 v[136:139], v237 offset:24576
  v_mfma_f32_16x16x32_bf16 v[76:79], a[36:39], v[120:123], v[76:79]
  s_mul_i32 s81, s81, 196608
  ds_read_b128 a[64:67], v232 offset:16384
  v_mfma_f32_16x16x32_bf16 v[80:83], a[40:43], v[120:123], v[80:83]
  v_mfma_f32_16x16x32_bf16 v[84:87], a[44:47], v[120:123], v[84:87]
  ds_read_b128 a[68:71], v232 offset:18432
  s_waitcnt lgkmcnt(6)
  v_mfma_f32_16x16x32_bf16 v[88:91], v[8:11], v[124:127], v[88:91]
  s_add_u32 m0, s68, 23552
  s_waitcnt lgkmcnt(4)
  v_mfma_f32_16x16x32_bf16 v[108:111], v[8:11], v[128:131], v[108:111]
  s_waitcnt lgkmcnt(3)
  v_mfma_f32_16x16x32_bf16 v[148:151], v[8:11], v[132:135], v[148:151]
  buffer_load_dwordx4 v26, s[8:11], s81 offen offset:1024 lds
  ds_read_b128 a[72:75], v232 offset:20480
  v_mfma_f32_16x16x32_bf16 v[152:155], v[132:135], v[132:135], v[152:155]
  s_waitcnt lgkmcnt(3)
  v_mfma_f32_16x16x32_bf16 v[148:151], v[8:11], v[136:139], v[148:151]
  v_mfma_f32_16x16x32_bf16 v[152:155], v[136:139], v[136:139], v[152:155]
  buffer_load_dwordx4 v26, s[8:11], s81 offen offset:2048 lds
  ds_read_b128 a[76:79], v232 offset:22528
  v_mfma_f32_16x16x32_bf16 v[56:59], a[48:51], v[124:127], v[56:59]
  v_mfma_f32_16x16x32_bf16 v[60:63], a[52:55], v[124:127], v[60:63]
  v_mfma_f32_16x16x32_bf16 v[64:67], a[56:59], v[124:127], v[64:67]
  ds_read_b64_tr_b16 v[116:117], v235 offset:16384
  ds_read_b64_tr_b16 v[118:119], v235 offset:16896
  s_sub_u32 s49, 0, s43
  v_mfma_f32_16x16x32_bf16 v[68:71], a[60:63], v[124:127], v[68:71]
  s_add_u32 s57, s57, 128
  ds_read_b64_tr_b16 v[120:121], v235 offset:17408
  ds_read_b64_tr_b16 v[122:123], v235 offset:17920
  s_and_b32 s49, s49, 7
  v_mfma_f32_16x16x32_bf16 v[72:75], a[48:51], v[128:131], v[72:75]
  s_and_b32 s57, s57, 0x380
  ds_read_b128 a[80:83], v233 offset:16384
  s_lshl_b32 s49, s49, 13
  s_lshl_b32 s50, s47, 12
  v_mfma_f32_16x16x32_bf16 v[76:79], a[52:55], v[128:131], v[76:79]
  s_add_u32 m0, s68, 114688
  s_add_u32 s49, s49, s50
  s_add_u32 s49, s49, 65536
  v_and_b32 v48, 31, v1
  v_mfma_f32_16x16x32_bf16 v[80:83], a[56:59], v[128:131], v[80:83]
  buffer_load_dwordx4 v24, s[4:7], s57 offen lds
  ds_read_b128 a[84:87], v233 offset:18432
  v_lshl_add_u32 v48, v48, 7, s49
  v_mfma_f32_16x16x32_bf16 v[84:87], a[60:63], v[128:131], v[84:87]
  buffer_load_dwordx4 v25, s[4:7], s57 offen offset:1024 lds
  v_lshl_add_u32 v48, v6, 3, v48
  s_waitcnt lgkmcnt(4)
  v_mfma_f32_16x16x32_bf16 v[88:91], v[8:11], v[116:119], v[88:91]
  s_add_u32 m0, s68, 31744
  ds_read_b128 a[88:91], v233 offset:20480
  s_lshl_b32 s50, s48, 2
  v_bfe_u32 v49, v1, 1, 3
  s_waitcnt lgkmcnt(3)
  v_mfma_f32_16x16x32_bf16 v[108:111], v[8:11], v[120:123], v[108:111]
  buffer_load_dwordx4 v243, s[8:11], s81 offen offset:1024 lds
  v_xor_b32 v49, s50, v49
  v_mfma_f32_16x16x32_bf16 v[56:59], a[64:67], v[116:119], v[56:59]
  buffer_load_dwordx4 v243, s[8:11], s81 offen offset:2048 lds
  ds_read_b128 a[92:95], v233 offset:22528
  v_lshl_add_u32 v48, v49, 4, v48
  v_xor_b32 v49, 16, v48
  v_mfma_f32_16x16x32_bf16 v[60:63], a[68:71], v[116:119], v[60:63]
  s_cmp_eq_u32 s3, 2
  s_cbranch_scc1 L_touch
L_tb2:
  v_xor_b32 v50, 32, v48
  v_xor_b32 v51, 48, v48
  s_waitcnt vmcnt(10)
  s_barrier
  v_mfma_f32_16x16x32_bf16 v[64:67], a[72:75], v[116:119], v[64:67]
  ds_read_b64_tr_b16 v[124:125], v234 offset:0
  ds_read_b64_tr_b16 v[126:127], v234 offset:512
  v_mfma_f32_16x16x32_bf16 v[68:71], a[76:79], v[116:119], v[68:71]
  s_bfe_u32 s81, s56, 0x40014
  ds_read_b64_tr_b16 v[128:129], v234 offset:1024
  ds_read_b64_tr_b16 v[130:131], v234 offset:1536
  v_mfma_f32_16x16x32_bf16 v[72:75], a[64:67], v[120:123], v[72:75]
  ds_read_b128 v[132:135], v236 offset:32768
  ds_read_b128 v[136:139], v237 offset:32768
  v_mfma_f32_16x16x32_bf16 v[76:79], a[68:71], v[120:123], v[76:79]
  s_mul_i32 s81, s81, 196608
  ds_read_b128 a[96:99], v232 offset:24576
  v_mfma_f32_16x16x32_bf16 v[80:83], a[72:75], v[120:123], v[80:83]
  v_mfma_f32_16x16x32_bf16 v[84:87], a[76:79], v[120:123], v[84:87]
  ds_read_b128 a[100:103], v232 offset:26624
  s_waitcnt lgkmcnt(6)
  v_mfma_f32_16x16x32_bf16 v[88:91], v[8:11], v[124:127], v[88:91]
  s_add_u32 m0, s68, 39936
  s_waitcnt lgkmcnt(4)
  v_mfma_f32_16x16x32_bf16 v[108:111], v[8:11], v[128:131], v[108:111]
  s_waitcnt lgkmcnt(3)
  v_mfma_f32_16x16x32_bf16 v[148:151], v[8:11], v[132:135], v[148:151]
  buffer_load_dwordx4 v26, s[8:11], s81 offen offset:1024 lds
  ds_read_b128 a[104:107], v232 offset:28672
  v_mfma_f32_16x16x32_bf16 v[152:155], v[132:135], v[132:135], v[152:155]
  s_waitcnt lgkmcnt(3)
  v_mfma_f32_16x16x32_bf16 v[148:151], v[8:11], v[136:139], v[148:151]
  v_mfma_f32_16x16x32_bf16 v[152:155], v[136:139], v[136:139], v[152:155]
  buffer_load_dwordx4 v26, s[8:11], s81 offen offset:2048 lds
  ds_read_b128 a[108:111], v232 offset:30720
  v_mfma_f32_16x16x32_bf16 v[56:59], a[80:83], v[124:127], v[56:59]
  v_mfma_f32_16x16x32_bf16 v[60:63], a[84:87], v[124:127], v[60:63]
  v_mfma_f32_16x16x32_bf16 v[64:67], a[88:91], v[124:127], v[64:67]
  ds_read_b64_tr_b16 v[116:117], v234 offset:8192
  ds_read_b64_tr_b16 v[118:119], v234 offset:8704
  v_mfma_f32_16x16x32_bf16 v[68:71], a[92:95], v[124:127], v[68:71]
  s_add_u32 s57, s57, 128
  ds_read_b64_tr_b16 v[120:121], v234 offset:9216
  ds_read_b64_tr_b16 v[122:123], v234 offset:9728
  v_mfma_f32_16x16x32_bf16 v[72:75], a[80:83], v[128:131], v[72:75]
  s_and_b32 s57, s57, 0x380
  ds_read_b128 a[112:115], v233 offset:24576
  v_bfe_u32 v224, v12, 0, 8
  v_mfma_f32_16x16x32_bf16 v[76:79], a[84:87], v[128:131], v[76:79]
  s_add_u32 m0, s68, 122880
  v_bfe_u32 v225, v12, 8, 8
  v_bfe_u32 v226, v12, 16, 8
  v_mfma_f32_16x16x32_bf16 v[80:83], a[88:91], v[128:131], v[80:83]
  buffer_load_dwordx4 v24, s[4:7], s57 offen lds
  ds_read_b128 a[116:119], v233 offset:26624
  v_mfma_f32_16x16x32_bf16 v[84:87], a[92:95], v[128:131], v[84:87]
  buffer_load_dwordx4 v25, s[4:7], s57 offen offset:1024 lds
  s_waitcnt lgkmcnt(4)
  v_mfma_f32_16x16x32_bf16 v[88:91], v[8:11], v[116:119], v[88:91]
  s_add_u32 m0, s68, 48128
  ds_read_b128 a[120:123], v233 offset:28672
  v_bfe_u32 v227, v12, 24, 8
  s_waitcnt lgkmcnt(3)
  v_mfma_f32_16x16x32_bf16 v[108:111], v[8:11], v[120:123], v[108:111]
L_pad1:
  s_cbranch_execz L_padback
  buffer_load_dwordx4 v243, s[8:11], s81 offen offset:1024 lds
  v_mfma_f32_16x16x32_bf16 v[56:59], a[96:99], v[116:119], v[56:59]
  buffer_load_dwordx4 v243, s[8:11], s81 offen offset:2048 lds
  ds_read_b128 a[124:127], v233 offset:30720
  v_mfma_f32_16x16x32_bf16 v[60:63], a[100:103], v[116:119], v[60:63]
  s_cmp_eq_u32 s3, 3
  s_cbranch_scc1 L_touch
L_tb3:
  s_waitcnt vmcnt(10)
  s_barrier
  v_mfma_f32_16x16x32_bf16 v[64:67], a[104:107], v[116:119], v[64:67]
  ds_read_b64_tr_b16 v[124:125], v234 offset:16384
  ds_read_b64_tr_b16 v[126:127], v234 offset:16896
  v_mfma_f32_16x16x32_bf16 v[68:71], a[108:111], v[116:119], v[68:71]
  s_bfe_u32 s81, s56, 0x40018
  ds_read_b64_tr_b16 v[128:129], v234 offset:17408
  ds_read_b64_tr_b16 v[130:131], v234 offset:17920
  v_mfma_f32_16x16x32_bf16 v[72:75], a[96:99], v[120:123], v[72:75]
  ds_read_b128 v[132:135], v236 offset:40960
  ds_read_b128 v[136:139], v237 offset:40960
  v_mfma_f32_16x16x32_bf16 v[76:79], a[100:103], v[120:123], v[76:79]
  s_mul_i32 s81, s81, 196608
  ds_read_b128 a[128:131], v232 offset:32768
  v_mfma_f32_16x16x32_bf16 v[80:83], a[104:107], v[120:123], v[80:83]
  v_mfma_f32_16x16x32_bf16 v[84:87], a[108:111], v[120:123], v[84:87]
  ds_read_b128 a[132:135], v232 offset:34816
  s_waitcnt lgkmcnt(6)
  v_mfma_f32_16x16x32_bf16 v[88:91], v[8:11], v[124:127], v[88:91]
  s_add_u32 m0, s68, 56320
  s_waitcnt lgkmcnt(4)
  v_mfma_f32_16x16x32_bf16 v[108:111], v[8:11], v[128:131], v[108:111]
  s_waitcnt lgkmcnt(3)
  v_mfma_f32_16x16x32_bf16 v[148:151], v[8:11], v[132:135], v[148:151]
  buffer_load_dwordx4 v26, s[8:11], s81 offen offset:1024 lds
  ds_read_b128 a[136:139], v232 offset:36864
  v_mfma_f32_16x16x32_bf16 v[152:155], v[132:135], v[132:135], v[152:155]
  s_waitcnt lgkmcnt(3)
  v_mfma_f32_16x16x32_bf16 v[148:151], v[8:11], v[136:139], v[148:151]
  v_mfma_f32_16x16x32_bf16 v[152:155], v[136:139], v[136:139], v[152:155]
  buffer_load_dwordx4 v26, s[8:11], s81 offen offset:2048 lds
  ds_read_b128 a[140:143], v232 offset:38912
  v_mfma_f32_16x16x32_bf16 v[56:59], a[112:115], v[124:127], v[56:59]
  v_mfma_f32_16x16x32_bf16 v[60:63], a[116:119], v[124:127], v[60:63]
  v_mfma_f32_16x16x32_bf16 v[64:67], a[120:123], v[124:127], v[64:67]
  ds_read_b64_tr_b16 v[116:117], v234 offset:24576
  ds_read_b64_tr_b16 v[118:119], v234 offset:25088
  v_mfma_f32_16x16x32_bf16 v[68:71], a[124:127], v[124:127], v[68:71]
  s_add_u32 m0, s68, 130048
  ds_read_b64_tr_b16 v[120:121], v234 offset:25600
  ds_read_b64_tr_b16 v[122:123], v234 offset:26112
  v_mfma_f32_16x16x32_bf16 v[72:75], a[112:115], v[128:131], v[72:75]
  buffer_load_dwordx4 v243, s[8:11], s81 offen offset:1024 lds
  ds_read_b128 a[144:147], v233 offset:32768
  v_mfma_f32_16x16x32_bf16 v[76:79], a[116:119], v[128:131], v[76:79]
  buffer_load_dwordx4 v243, s[8:11], s81 offen offset:2048 lds
  v_mfma_f32_16x16x32_bf16 v[80:83], a[120:123], v[128:131], v[80:83]
  s_bfe_u32 s81, s56, 0x4001c
  ds_read_b128 a[148:151], v233 offset:34816
  v_mfma_f32_16x16x32_bf16 v[84:87], a[124:127], v[128:131], v[84:87]
  s_mul_i32 s81, s81, 196608
  s_waitcnt lgkmcnt(4)
  v_mfma_f32_16x16x32_bf16 v[88:91], v[8:11], v[116:119], v[88:91]
  s_add_u32 m0, s68, 138240
  ds_read_b128 a[152:155], v233 offset:36864
  s_waitcnt lgkmcnt(3)
  v_mfma_f32_16x16x32_bf16 v[108:111], v[8:11], v[120:123], v[108:111]
  buffer_load_dwordx4 v26, s[8:11], s81 offen offset:1024 lds
  v_mfma_f32_16x16x32_bf16 v[56:59], a[128:131], v[116:119], v[56:59]
  buffer_load_dwordx4 v26, s[8:11], s81 offen offset:2048 lds
  ds_read_b128 a[156:159], v233 offset:38912
  v_mfma_f32_16x16x32_bf16 v[60:63], a[132:135], v[116:119], v[60:63]
  s_cmp_eq_u32 s3, 4
  s_cbranch_scc1 L_touch
L_tb4:
  s_waitcnt vmcnt(10)
  s_barrier
  v_mfma_f32_16x16x32_bf16 v[64:67], a[136:139], v[116:119], v[64:67]
  ds_read_b64_tr_b16 v[124:125], v234 offset:32768
  ds_read_b64_tr_b16 v[126:127], v234 offset:33280
  v_mfma_f32_16x16x32_bf16 v[68:71], a[140:143], v[116:119], v[68:71]
  s_add_u32 m0, s68, 146432
  ds_read_b64_tr_b16 v[128:129], v234 offset:33792
  ds_read_b64_tr_b16 v[130:131], v234 offset:34304
  v_mfma_f32_16x16x32_bf16 v[72:75], a[128:131], v[120:123], v[72:75]
  ds_read_b128 v[132:135], v236 offset:49152
  ds_read_b128 v[136:139], v237 offset:49152
  v_mfma_f32_16x16x32_bf16 v[76:79], a[132:135], v[120:123], v[76:79]
  ds_read_b128 a[160:163], v232 offset:40960
  v_mfma_f32_16x16x32_bf16 v[80:83], a[136:139], v[120:123], v[80:83]
  v_mfma_f32_16x16x32_bf16 v[84:87], a[140:143], v[120:123], v[84:87]
  buffer_load_dwordx4 v243, s[8:11], s81 offen offset:1024 lds
  ds_read_b128 a[164:167], v232 offset:43008
  s_waitcnt lgkmcnt(6)
  v_mfma_f32_16x16x32_bf16 v[88:91], v[8:11], v[124:127], v[88:91]
  s_waitcnt lgkmcnt(4)
  v_mfma_f32_16x16x32_bf16 v[108:111], v[8:11], v[128:131], v[108:111]
  s_waitcnt lgkmcnt(3)
  v_mfma_f32_16x16x32_bf16 v[148:151], v[8:11], v[132:135], v[148:151]
  ds_read_b128 a[168:171], v232 offset:45056
  v_mfma_f32_16x16x32_bf16 v[152:155], v[132:135], v[132:135], v[152:155]
  buffer_load_dwordx4 v243, s[8:11], s81 offen offset:2048 lds
  s_waitcnt lgkmcnt(3)
  v_mfma_f32_16x16x32_bf16 v[148:151], v[8:11], v[136:139], v[148:151]
  v_mfma_f32_16x16x32_bf16 v[152:155], v[136:139], v[136:139], v[152:155]
  ds_read_b128 a[172:175], v232 offset:47104
  v_mfma_f32_16x16x32_bf16 v[56:59], a[144:147], v[124:127], v[56:59]
  v_mfma_f32_16x16x32_bf16 v[60:63], a[148:151], v[124:127], v[60:63]
  v_mfma_f32_16x16x32_bf16 v[64:67], a[152:155], v[124:127], v[64:67]
  ds_read_b64_tr_b16 v[116:117], v234 offset:40960
  ds_read_b64_tr_b16 v[118:119], v234 offset:41472
  v_mfma_f32_16x16x32_bf16 v[68:71], a[156:159], v[124:127], v[68:71]
  s_bfe_u32 s81, s56, 0x40000
  s_mul_i32 s81, s81, 196608
  ds_read_b64_tr_b16 v[120:121], v234 offset:41984
  ds_read_b64_tr_b16 v[122:123], v234 offset:42496
  v_mfma_f32_16x16x32_bf16 v[72:75], a[144:147], v[128:131], v[72:75]
  s_add_u32 m0, s54, 4096
  s_nop 0
  buffer_load_dwordx4 v243, s[8:11], s81 offen lds
  ds_read_b128 a[176:179], v233 offset:40960
  v_mfma_f32_16x16x32_bf16 v[76:79], a[148:151], v[128:131], v[76:79]
  s_bfe_u32 s81, s56, 0x40004
  v_mfma_f32_16x16x32_bf16 v[80:83], a[152:155], v[128:131], v[80:83]
  s_mul_i32 s81, s81, 196608
  s_add_u32 m0, s54, 8192
  ds_read_b128 a[180:183], v233 offset:43008
  v_mfma_f32_16x16x32_bf16 v[84:87], a[156:159], v[128:131], v[84:87]
  buffer_load_dwordx4 v26, s[8:11], s81 offen lds
  s_add_u32 m0, s54, 12288
  s_waitcnt lgkmcnt(4)
  v_mfma_f32_16x16x32_bf16 v[88:91], v[8:11], v[116:119], v[88:91]
  buffer_load_dwordx4 v243, s[8:11], s81 offen lds
  ds_read_b128 a[184:187], v233 offset:45056
  s_waitcnt lgkmcnt(3)
  v_mfma_f32_16x16x32_bf16 v[108:111], v[8:11], v[120:123], v[108:111]
  s_bfe_u32 s81, s56, 0x40008
  s_mul_i32 s81, s81, 196608
  v_mfma_f32_16x16x32_bf16 v[56:59], a[160:163], v[116:119], v[56:59]
  s_add_u32 m0, s54, 16384
  s_nop 0
  buffer_load_dwordx4 v26, s[8:11], s81 offen lds
  ds_read_b128 a[188:191], v233 offset:47104
  v_mfma_f32_16x16x32_bf16 v[60:63], a[164:167], v[116:119], v[60:63]
  s_cmp_eq_u32 s3, 5
  s_cbranch_scc1 L_touch
L_tb5:
  s_waitcnt vmcnt(10)
  s_barrier
  v_mfma_f32_16x16x32_bf16 v[64:67], a[168:171], v[116:119], v[64:67]
  ds_read_b64_tr_b16 v[124:125], v234 offset:49152
  ds_read_b64_tr_b16 v[126:127], v234 offset:49664
  v_mfma_f32_16x16x32_bf16 v[68:71], a[172:175], v[116:119], v[68:71]
  s_add_u32 m0, s54, 20480
  ds_read_b64_tr_b16 v[128:129], v234 offset:50176
  ds_read_b64_tr_b16 v[130:131], v234 offset:50688
  v_mfma_f32_16x16x32_bf16 v[72:75], a[160:163], v[120:123], v[72:75]
  ds_read_b128 v[132:135], v236 offset:57344
  ds_read_b128 v[136:139], v237 offset:57344
  v_mfma_f32_16x16x32_bf16 v[76:79], a[164:167], v[120:123], v[76:79]
  buffer_load_dwordx4 v243, s[8:11], s81 offen lds
  ds_read_b128 a[192:195], v232 offset:49152
  v_mfma_f32_16x16x32_bf16 v[80:83], a[168:171], v[120:123], v[80:83]
  v_mfma_f32_16x16x32_bf16 v[84:87], a[172:175], v[120:123], v[84:87]
  s_bfe_u32 s81, s56, 0x4000c
  ds_read_b128 a[196:199], v232 offset:51200
  s_waitcnt lgkmcnt(6)
  v_mfma_f32_16x16x32_bf16 v[88:91], v[8:11], v[124:127], v[88:91]
  s_waitcnt lgkmcnt(4)
  v_mfma_f32_16x16x32_bf16 v[108:111], v[8:11], v[128:131], v[108:111]
  s_mul_i32 s81, s81, 196608
  s_waitcnt lgkmcnt(3)
  v_mfma_f32_16x16x32_bf16 v[148:151], v[8:11], v[132:135], v[148:151]
  ds_read_b128 a[200:203], v232 offset:53248
  v_mfma_f32_16x16x32_bf16 v[152:155], v[132:135], v[132:135], v[152:155]
  s_add_u32 m0, s54, 24576
  s_waitcnt lgkmcnt(3)
  v_mfma_f32_16x16x32_bf16 v[148:151], v[8:11], v[136:139], v[148:151]
  v_mfma_f32_16x16x32_bf16 v[152:155], v[136:139], v[136:139], v[152:155]
  buffer_load_dwordx4 v26, s[8:11], s81 offen lds
  ds_read_b128 a[204:207], v232 offset:55296
  v_mfma_f32_16x16x32_bf16 v[56:59], a[176:179], v[124:127], v[56:59]
  v_mfma_f32_16x16x32_bf16 v[60:63], a[180:183], v[124:127], v[60:63]
  v_mfma_f32_16x16x32_bf16 v[64:67], a[184:187], v[124:127], v[64:67]
  ds_read_b64_tr_b16 v[116:117], v234 offset:57344
  ds_read_b64_tr_b16 v[118:119], v234 offset:57856
  s_nop 0
  v_cndmask_b32 v152, v152, v153, s[58:59]
  v_mfma_f32_16x16x32_bf16 v[68:71], a[188:191], v[124:127], v[68:71]
  s_add_u32 m0, s54, 28672
  ds_read_b64_tr_b16 v[120:121], v234 offset:58368
  ds_read_b64_tr_b16 v[122:123], v234 offset:58880
  v_cndmask_b32 v152, v152, v154, s[60:61]
  v_mfma_f32_16x16x32_bf16 v[72:75], a[176:179], v[128:131], v[72:75]
  buffer_load_dwordx4 v243, s[8:11], s81 offen lds
  ds_read_b128 a[208:211], v233 offset:49152
  v_cndmask_b32 v152, v152, v155, s[62:63]
  v_mfma_f32_16x16x32_bf16 v[76:79], a[180:183], v[128:131], v[76:79]
  s_bfe_u32 s81, s56, 0x40010
  v_mul_f32 v55, 0x3b000000, v148
  v_mul_f32 v54, 0x3b000000, v152
  v_fma_f32 v54, -v55, v55, v54
  v_mfma_f32_16x16x32_bf16 v[80:83], a[184:187], v[128:131], v[80:83]
  s_mul_i32 s81, s81, 196608
  ds_read_b128 a[212:215], v233 offset:51200
  v_max_f32 v54, 0, v54
  v_add_f32 v54, 0x3727c5ac, v54
  v_mfma_f32_16x16x32_bf16 v[84:87], a[188:191], v[128:131], v[84:87]
  v_rsq_f32 v54, v54
  s_waitcnt lgkmcnt(4)
  v_mfma_f32_16x16x32_bf16 v[88:91], v[8:11], v[116:119], v[88:91]
  s_add_u32 m0, s54, 32768
  ds_read_b128 a[216:219], v233 offset:53248
  v_mul_f32 v55, v55, v54
  s_waitcnt lgkmcnt(3)
  v_mfma_f32_16x16x32_bf16 v[108:111], v[8:11], v[120:123], v[108:111]
  buffer_load_dwordx4 v26, s[8:11], s81 offen lds
  v_mfma_f32_16x16x32_bf16 v[56:59], a[192:195], v[116:119], v[56:59]
  s_cmp_eq_u32 s3, 6
  s_cbranch_scc1 L_touch
L_tb6:
  ds_read_b128 a[220:223], v233 offset:55296
  v_mfma_f32_16x16x32_bf16 v[60:63], a[196:199], v[116:119], v[60:63]
  s_mov_b32 exec_lo, 0x00f0000f
  s_mov_b32 exec_hi, 0xf0000f00
  ds_write2_b32 v238, v54, v55 offset0:0 offset1:64
  s_mov_b64 exec, -1
  s_waitcnt vmcnt(10) lgkmcnt(0)
  s_barrier
  v_mfma_f32_16x16x32_bf16 v[64:67], a[200:203], v[116:119], v[64:67]
  ds_read_b64_tr_b16 v[124:125], v235 offset:0
  ds_read_b64_tr_b16 v[126:127], v235 offset:512
  v_mfma_f32_16x16x32_bf16 v[68:71], a[204:207], v[116:119], v[68:71]
  s_add_u32 m0, s54, 36864
  ds_read_b64_tr_b16 v[128:129], v235 offset:1024
  ds_read_b64_tr_b16 v[130:131], v235 offset:1536
  v_mfma_f32_16x16x32_bf16 v[72:75], a[192:195], v[120:123], v[72:75]
  buffer_load_dwordx4 v243, s[8:11], s81 offen lds
  ds_read_b128 a[224:227], v232 offset:57344
  v_mfma_f32_16x16x32_bf16 v[76:79], a[196:199], v[120:123], v[76:79]
  ds_read_b128 a[228:231], v232 offset:59392
  v_mfma_f32_16x16x32_bf16 v[80:83], a[200:203], v[120:123], v[80:83]
  s_bfe_u32 s81, s56, 0x40014
  ds_read_b128 a[232:235], v232 offset:61440
  v_mfma_f32_16x16x32_bf16 v[84:87], a[204:207], v[120:123], v[84:87]
  s_mul_i32 s81, s81, 196608
  s_waitcnt lgkmcnt(5)
  v_mfma_f32_16x16x32_bf16 v[88:91], v[8:11], v[124:127], v[88:91]
  ds_read_b128 a[236:239], v232 offset:63488
  s_waitcnt lgkmcnt(4)
  v_mfma_f32_16x16x32_bf16 v[108:111], v[8:11], v[128:131], v[108:111]
  s_add_u32 m0, s54, 40960
  ds_read_b128 v[156:159], v239 offset:0
  v_mfma_f32_16x16x32_bf16 v[56:59], a[208:211], v[124:127], v[56:59]
  buffer_load_dwordx4 v26, s[8:11], s81 offen lds
  ds_read_b128 v[172:175], v239 offset:256
  v_mfma_f32_16x16x32_bf16 v[60:63], a[212:215], v[124:127], v[60:63]
  v_mfma_f32_16x16x32_bf16 v[64:67], a[216:219], v[124:127], v[64:67]
  ds_read_b64_tr_b16 v[116:117], v235 offset:8192
  ds_read_b64_tr_b16 v[118:119], v235 offset:8704
  v_mfma_f32_16x16x32_bf16 v[68:71], a[220:223], v[124:127], v[68:71]
  s_add_u32 m0, s54, 45056
  ds_read_b64_tr_b16 v[120:121], v235 offset:9216
  ds_read_b64_tr_b16 v[122:123], v235 offset:9728
  v_mfma_f32_16x16x32_bf16 v[72:75], a[208:211], v[128:131], v[72:75]
  buffer_load_dwordx4 v243, s[8:11], s81 offen lds
  ds_read_b128 a[240:243], v233 offset:57344
  v_mfma_f32_16x16x32_bf16 v[76:79], a[212:215], v[128:131], v[76:79]
  s_bfe_u32 s81, s56, 0x40018
  ds_read_b128 a[244:247], v233 offset:59392
  v_mfma_f32_16x16x32_bf16 v[80:83], a[216:219], v[128:131], v[80:83]
  s_mul_i32 s81, s81, 196608
  ds_read_b128 a[248:251], v233 offset:61440
  v_mfma_f32_16x16x32_bf16 v[84:87], a[220:223], v[128:131], v[84:87]
  s_waitcnt lgkmcnt(5)
  v_mfma_f32_16x16x32_bf16 v[88:91], v[8:11], v[116:119], v[88:91]
  s_add_u32 m0, s54, 49152
  ds_read_b128 a[252:255], v233 offset:63488
  s_waitcnt lgkmcnt(4)
  v_mfma_f32_16x16x32_bf16 v[108:111], v[8:11], v[120:123], v[108:111]
  buffer_load_dwordx4 v26, s[8:11], s81 offen lds
  ds_read_b128 v[160:163], v239 offset:64
  v_mfma_f32_16x16x32_bf16 v[56:59], a[224:227], v[116:119], v[56:59]
  s_cmp_eq_u32 s3, 7
  s_cbranch_scc1 L_touch
L_tb7:
  ds_read_b128 v[176:179], v239 offset:320
  v_mfma_f32_16x16x32_bf16 v[60:63], a[228:231], v[116:119], v[60:63]
  s_waitcnt vmcnt(12)
  s_barrier
  v_mfma_f32_16x16x32_bf16 v[64:67], a[232:235], v[116:119], v[64:67]
  ds_read_b64_tr_b16 v[124:125], v235 offset:16384
  ds_read_b64_tr_b16 v[126:127], v235 offset:16896
  v_mfma_f32_16x16x32_bf16 v[68:71], a[236:239], v[116:119], v[68:71]
  s_add_u32 m0, s54, 53248
  ds_read_b64_tr_b16 v[128:129], v235 offset:17408
  ds_read_b64_tr_b16 v[130:131], v235 offset:17920
  v_mfma_f32_16x16x32_bf16 v[72:75], a[224:227], v[120:123], v[72:75]
  buffer_load_dwordx4 v243, s[8:11], s81 offen lds
  ds_read_b128 v[164:167], v239 offset:128
  v_mfma_f32_16x16x32_bf16 v[76:79], a[228:231], v[120:123], v[76:79]
  v_mfma_f32_16x16x32_bf16 v[80:83], a[232:235], v[120:123], v[80:83]
  s_bfe_u32 s81, s56, 0x4001c
  ds_read_b128 v[180:183], v239 offset:384
  v_mfma_f32_16x16x32_bf16 v[84:87], a[236:239], v[120:123], v[84:87]
  s_mul_i32 s81, s81, 196608
  s_waitcnt lgkmcnt(4)
  v_mfma_f32_16x16x32_bf16 v[88:91], v[8:11], v[124:127], v[88:91]
  ds_read_b128 v[168:171], v239 offset:192
  s_waitcnt lgkmcnt(3)
  v_mfma_f32_16x16x32_bf16 v[108:111], v[8:11], v[128:131], v[108:111]
  s_add_u32 m0, s54, 57344
  v_mfma_f32_16x16x32_bf16 v[56:59], a[240:243], v[124:127], v[56:59]
  buffer_load_dwordx4 v26, s[8:11], s81 offen lds
  ds_read_b128 v[184:187], v239 offset:448
  v_mfma_f32_16x16x32_bf16 v[60:63], a[244:247], v[124:127], v[60:63]
  v_mfma_f32_16x16x32_bf16 v[64:67], a[248:251], v[124:127], v[64:67]
  s_lshl2_add_u32 s51, s44, s46
  s_lshl_b32 s49, s51, 15
  ds_read_b64 v[16:17], v48
  ds_read_b64 v[18:19], v49
  v_mfma_f32_16x16x32_bf16 v[68:71], a[252:255], v[124:127], v[68:71]
  s_lshl_b32 s50, s45, 6
  s_add_u32 s49, s49, s50
  ds_read_b64 v[20:21], v50
  v_mfma_f32_16x16x32_bf16 v[72:75], a[240:243], v[128:131], v[72:75]
  s_add_u32 s49, s49, 1048576
  s_lshl_b32 s3, s51, 11
  ds_read_b64 v[22:23], v51
  v_mfma_f32_16x16x32_bf16 v[76:79], a[244:247], v[128:131], v[76:79]
  s_add_u32 s50, s50, s3
  s_add_u32 s50, s50, 131072
  ds_read2_b32 v[188:189], v240 offset0:0 offset1:64
  ds_read2_b32 v[190:191], v240 offset0:16 offset1:80
  v_mfma_f32_16x16x32_bf16 v[80:83], a[248:251], v[128:131], v[80:83]
  s_mul_i32 s28, s44, 0x11111111
  s_add_u32 s28, s28, 0x76543210
  ds_read2_b32 v[192:193], v240 offset0:32 offset1:96
  v_mfma_f32_16x16x32_bf16 v[84:87], a[252:255], v[128:131], v[84:87]
  s_and_b32 s28, s28, 0x77777777
  ds_read2_b32 v[194:195], v240 offset0:48 offset1:112
  s_add_u32 m0, s54, 61440
  s_nop 0
  buffer_load_dwordx4 v243, s[8:11], s81 offen lds
  v_pk_fma_f32 v[56:57], v[56:57], v[156:157], s[64:65]
  v_pk_fma_f32 v[56:57], v[172:173], v[88:89], v[56:57] neg_lo:[1,0,0] neg_hi:[1,0,0]
  v_pk_mul_f32 v[220:221], v[56:57], s[66:67]
  v_max_f32 v56, s64, v56
  v_exp_f32_e64 v220, v220 clamp
  v_exp_f32_e64 v221, v221 clamp
  v_max_f32 v57, s64, v57
  v_pk_add_f32 v[56:57], v[56:57], v[220:221]
  v_cvt_pk_bf16_f32 v196, v56, v57
  v_pk_fma_f32 v[58:59], v[58:59], v[158:159], s[64:65]
  v_pk_fma_f32 v[58:59], v[174:175], v[88:89], v[58:59] neg_lo:[1,0,0] neg_hi:[1,0,0]
  v_pk_mul_f32 v[220:221], v[58:59], s[66:67]
  s_lshl2_add_u32 s52, s2, s46
  s_mul_i32 s52, s52, 1408
  s_mov_b64 exec, 0x7ff
  buffer_load_dword v255, v0, s[24:27], s52 offen
  s_lshl_b32 s51, s74, 12
  s_mul_i32 s55, s74, 11264
  s_mov_b64 exec, 15
  buffer_load_dword v255, v15, s[12:15], s51 offen offset:384
  s_mov_b64 exec, -1
  v_max_f32 v58, s64, v58
  v_exp_f32_e64 v220, v220 clamp
  v_exp_f32_e64 v221, v221 clamp
  v_max_f32 v59, s64, v59
  v_pk_add_f32 v[58:59], v[58:59], v[220:221]
  v_cvt_pk_bf16_f32 v197, v58, v59
  v_pk_fma_f32 v[60:61], v[60:61], v[160:161], s[64:65]
  v_pk_fma_f32 v[60:61], v[176:177], v[88:89], v[60:61] neg_lo:[1,0,0] neg_hi:[1,0,0]
  v_pk_mul_f32 v[220:221], v[60:61], s[66:67]
  v_max_f32 v60, s64, v60
  v_exp_f32_e64 v220, v220 clamp
  v_exp_f32_e64 v221, v221 clamp
  v_max_f32 v61, s64, v61
  v_pk_add_f32 v[60:61], v[60:61], v[220:221]
  v_cvt_pk_bf16_f32 v198, v60, v61
  v_pk_fma_f32 v[62:63], v[62:63], v[162:163], s[64:65]
  v_pk_fma_f32 v[62:63], v[178:179], v[88:89], v[62:63] neg_lo:[1,0,0] neg_hi:[1,0,0]
  v_pk_mul_f32 v[220:221], v[62:63], s[66:67]
  v_max_f32 v62, s64, v62
  v_exp_f32_e64 v220, v220 clamp
  v_exp_f32_e64 v221, v221 clamp
  v_max_f32 v63, s64, v63
  v_pk_add_f32 v[62:63], v[62:63], v[220:221]
  v_cvt_pk_bf16_f32 v199, v62, v63
  s_waitcnt lgkmcnt(11)
  v_pk_fma_f32 v[64:65], v[64:65], v[164:165], s[64:65]
  s_waitcnt lgkmcnt(10)
  v_pk_fma_f32 v[64:65], v[180:181], v[88:89], v[64:65] neg_lo:[1,0,0] neg_hi:[1,0,0]
  v_pk_mul_f32 v[220:221], v[64:65], s[66:67]
  v_max_f32 v64, s64, v64
  v_exp_f32_e64 v220, v220 clamp
  v_exp_f32_e64 v221, v221 clamp
  v_max_f32 v65, s64, v65
  v_pk_add_f32 v[64:65], v[64:65], v[220:221]
  v_cvt_pk_bf16_f32 v200, v64, v65
  v_pk_fma_f32 v[66:67], v[66:67], v[166:167], s[64:65]
  v_pk_fma_f32 v[66:67], v[182:183], v[88:89], v[66:67] neg_lo:[1,0,0] neg_hi:[1,0,0]
  v_pk_mul_f32 v[220:221], v[66:67], s[66:67]
  v_max_f32 v66, s64, v66
  v_exp_f32_e64 v220, v220 clamp
  v_exp_f32_e64 v221, v221 clamp
  v_max_f32 v67, s64, v67
  v_pk_add_f32 v[66:67], v[66:67], v[220:221]
  v_cvt_pk_bf16_f32 v201, v66, v67
  s_waitcnt lgkmcnt(9)
  v_pk_fma_f32 v[68:69], v[68:69], v[168:169], s[64:65]
  s_waitcnt lgkmcnt(8)
  v_pk_fma_f32 v[68:69], v[184:185], v[88:89], v[68:69] neg_lo:[1,0,0] neg_hi:[1,0,0]
  v_pk_mul_f32 v[220:221], v[68:69], s[66:67]
  v_max_f32 v68, s64, v68
  v_exp_f32_e64 v220, v220 clamp
  v_exp_f32_e64 v221, v221 clamp
  v_max_f32 v69, s64, v69
  v_pk_add_f32 v[68:69], v[68:69], v[220:221]
  v_cvt_pk_bf16_f32 v202, v68, v69
  v_pk_fma_f32 v[70:71], v[70:71], v[170:171], s[64:65]
  v_pk_fma_f32 v[70:71], v[186:187], v[88:89], v[70:71] neg_lo:[1,0,0] neg_hi:[1,0,0]
  v_pk_mul_f32 v[220:221], v[70:71], s[66:67]
  v_max_f32 v70, s64, v70
  v_exp_f32_e64 v220, v220 clamp
  v_exp_f32_e64 v221, v221 clamp
  v_max_f32 v71, s64, v71
  v_pk_add_f32 v[70:71], v[70:71], v[220:221]
  v_cvt_pk_bf16_f32 v203, v70, v71
  v_pk_mul_f32 v[72:73], v[72:73], v[156:157]
  v_pk_fma_f32 v[72:73], v[172:173], v[108:109], v[72:73] neg_lo:[1,0,0] neg_hi:[1,0,0]
  v_cvt_pk_bf16_f32 v204, v72, v73
  v_pk_mul_f32 v[74:75], v[74:75], v[158:159]
  v_pk_fma_f32 v[74:75], v[174:175], v[108:109], v[74:75] neg_lo:[1,0,0] neg_hi:[1,0,0]
  v_cvt_pk_bf16_f32 v205, v74, v75
  v_pk_mul_f32 v[76:77], v[76:77], v[160:161]
  v_pk_fma_f32 v[76:77], v[176:177], v[108:109], v[76:77] neg_lo:[1,0,0] neg_hi:[1,0,0]
  v_cvt_pk_bf16_f32 v206, v76, v77
  v_pk_mul_f32 v[78:79], v[78:79], v[162:163]
  v_pk_fma_f32 v[78:79], v[178:179], v[108:109], v[78:79] neg_lo:[1,0,0] neg_hi:[1,0,0]
  v_cvt_pk_bf16_f32 v207, v78, v79
  v_pk_mul_f32 v[80:81], v[80:81], v[164:165]
  v_pk_fma_f32 v[80:81], v[180:181], v[108:109], v[80:81] neg_lo:[1,0,0] neg_hi:[1,0,0]
  v_cvt_pk_bf16_f32 v208, v80, v81
  v_pk_mul_f32 v[82:83], v[82:83], v[166:167]
  v_pk_fma_f32 v[82:83], v[182:183], v[108:109], v[82:83] neg_lo:[1,0,0] neg_hi:[1,0,0]
  v_cvt_pk_bf16_f32 v209, v82, v83
  v_pk_mul_f32 v[84:85], v[84:85], v[168:169]
  v_pk_fma_f32 v[84:85], v[184:185], v[108:109], v[84:85] neg_lo:[1,0,0] neg_hi:[1,0,0]
  v_cvt_pk_bf16_f32 v210, v84, v85
  v_pk_mul_f32 v[86:87], v[86:87], v[170:171]
  v_pk_fma_f32 v[86:87], v[186:187], v[108:109], v[86:87] neg_lo:[1,0,0] neg_hi:[1,0,0]
  v_cvt_pk_bf16_f32 v211, v86, v87
  s_waitcnt vmcnt(10) lgkmcnt(0)
  v_mfma_f32_16x16x32_bf16 v[148:151], v[196:199], v[204:207], 0
  s_barrier
  v_mfma_f32_16x16x32_bf16 v[148:151], v[200:203], v[208:211], v[148:151]
  ds_read_b64_tr_b16 v[116:117], v53 offset:0
  ds_read_b64_tr_b16 v[118:119], v53 offset:512
  v_mfma_f32_16x16x32_bf16 v[152:155], v[196:199], v[8:11], 0
  ds_read_b64_tr_b16 v[120:121], v52 offset:4096
  ds_read_b64_tr_b16 v[122:123], v52 offset:4608
  v_mfma_f32_16x16x32_bf16 v[152:155], v[200:203], v[8:11], v[152:155]
  ds_read_b64_tr_b16 v[124:125], v52 offset:8192
  ds_read_b64_tr_b16 v[126:127], v52 offset:8704
  v_and_or_b32 v148, v148, s79, v224
  v_and_or_b32 v149, v149, s79, v225
  v_and_or_b32 v150, v150, s79, v226
  v_and_or_b32 v151, v151, s79, v227
  buffer_store_dwordx4 v[148:151], v228, s[36:39], s49 offen sc1
  s_nop 0
  v_and_or_b32 v152, v152, s79, v224
  v_and_or_b32 v153, v153, s79, v225
  v_and_or_b32 v154, v154, s79, v226
  v_and_or_b32 v155, v155, s79, v227
  s_mov_b32 exec_lo, 0x00010001
  s_mov_b32 exec_hi, 0x00010001
  buffer_store_dwordx4 v[152:155], v229, s[36:39], s50 offen sc1
  s_mov_b64 exec, -1
  s_waitcnt lgkmcnt(4)
  v_mfma_f32_16x16x32_bf16 v[112:115], v[116:119], v[8:11], 0
  s_bfe_u32 s81, s28, 0x40000
  v_mfma_f32_16x16x32_bf16 v[92:95], v[116:119], a[0:3], 0
  s_lshl_b32 s81, s81, 16
  v_mfma_f32_16x16x32_bf16 v[96:99], v[116:119], a[4:7], 0
  ds_read_b64_tr_b16 v[128:129], v52 offset:12288
  ds_read_b64_tr_b16 v[130:131], v52 offset:12800
  v_mfma_f32_16x16x32_bf16 v[100:103], v[116:119], a[8:11], 0
  s_add_u32 m0, s68, 65536
  s_lshl1_add_u32 s74, s2, s46
  v_mfma_f32_16x16x32_bf16 v[104:107], v[116:119], a[12:15], 0
  s_waitcnt lgkmcnt(4)
  s_lshl_b32 s72, s74, 11
  v_mfma_f32_16x16x32_bf16 v[112:115], v[120:123], v[8:11], v[112:115]
  buffer_load_dwordx4 v30, s[12:15], s81 offen lds
  v_mfma_f32_16x16x32_bf16 v[92:95], v[120:123], a[16:19], v[92:95]
  s_lshl_b32 s74, s74, 6
  v_mfma_f32_16x16x32_bf16 v[96:99], v[120:123], a[20:23], v[96:99]
  ds_read_b64_tr_b16 v[116:117], v52 offset:16384
  ds_read_b64_tr_b16 v[118:119], v52 offset:16896
  v_mfma_f32_16x16x32_bf16 v[100:103], v[120:123], a[24:27], v[100:103]
  buffer_load_dwordx4 v31, s[12:15], s81 offen offset:1024 lds
  v_mfma_f32_16x16x32_bf16 v[104:107], v[120:123], a[28:31], v[104:107]
  s_waitcnt lgkmcnt(4)
  s_add_u32 s72, s72, 1048576
  v_mfma_f32_16x16x32_bf16 v[112:115], v[124:127], v[8:11], v[112:115]
  s_bfe_u32 s81, s28, 0x40004
  s_add_u32 s74, s74, 32768
  v_mfma_f32_16x16x32_bf16 v[92:95], v[124:127], a[32:35], v[92:95]
  s_lshl_b32 s81, s81, 16
  s_lshl_b32 s51, s2, 8
  v_mfma_f32_16x16x32_bf16 v[96:99], v[124:127], a[36:39], v[96:99]
  ds_read_b64_tr_b16 v[120:121], v52 offset:20480
  ds_read_b64_tr_b16 v[122:123], v52 offset:20992
  v_mfma_f32_16x16x32_bf16 v[100:103], v[124:127], a[40:43], v[100:103]
  s_add_u32 m0, s68, 73728
  s_add_u32 s51, s51, 131072
  v_mfma_f32_16x16x32_bf16 v[104:107], v[124:127], a[44:47], v[104:107]
  s_waitcnt lgkmcnt(4)
  s_lshl_b32 s52, s2, 3
  v_mfma_f32_16x16x32_bf16 v[112:115], v[128:131], v[8:11], v[112:115]
  s_add_u32 s52, s52, 65536
  v_mfma_f32_16x16x32_bf16 v[92:95], v[128:131], a[48:51], v[92:95]
  buffer_load_dwordx4 v30, s[12:15], s81 offen lds
  v_mfma_f32_16x16x32_bf16 v[96:99], v[128:131], a[52:55], v[96:99]
  ds_read_b64_tr_b16 v[124:125], v52 offset:24576
  ds_read_b64_tr_b16 v[126:127], v52 offset:25088
  v_mfma_f32_16x16x32_bf16 v[100:103], v[128:131], a[56:59], v[100:103]
  buffer_load_dwordx4 v31, s[12:15], s81 offen offset:1024 lds
  v_mfma_f32_16x16x32_bf16 v[104:107], v[128:131], a[60:63], v[104:107]
  s_waitcnt lgkmcnt(4)
  v_mfma_f32_16x16x32_bf16 v[112:115], v[116:119], v[8:11], v[112:115]
  s_bfe_u32 s81, s28, 0x40008
  v_mfma_f32_16x16x32_bf16 v[92:95], v[116:119], a[64:67], v[92:95]
  v_mfma_f32_16x16x32_bf16 v[96:99], v[116:119], a[68:71], v[96:99]
  ds_read_b64_tr_b16 v[128:129], v52 offset:28672
  ds_read_b64_tr_b16 v[130:131], v52 offset:29184
  v_mfma_f32_16x16x32_bf16 v[100:103], v[116:119], a[72:75], v[100:103]
  s_lshl_b32 s81, s81, 16
  v_mfma_f32_16x16x32_bf16 v[104:107], v[116:119], a[76:79], v[104:107]
  s_waitcnt lgkmcnt(4)
  s_cmp_lt_u32 s46, 2
  s_cselect_b32 s72, s72, s51
  s_cselect_b32 s74, s74, s52
  s_cselect_b32 s73, 1, 0
  v_mfma_f32_16x16x32_bf16 v[112:115], v[120:123], v[8:11], v[112:115]
  s_add_u32 m0, s68, 81920
  s_lshl2_add_u32 s51, s43, s46
  v_mfma_f32_16x16x32_bf16 v[92:95], v[120:123], a[80:83], v[92:95]
  s_waitcnt vmcnt(8)
  s_barrier
  s_cmp_eq_u32 s51, 2
  s_cselect_b32 s73, 1, s73
  v_mfma_f32_16x16x32_bf16 v[96:99], v[120:123], a[84:87], v[96:99]
  ds_read_b64_tr_b16 v[116:117], v52 offset:32768
  ds_read_b64_tr_b16 v[118:119], v52 offset:33280
  v_mfma_f32_16x16x32_bf16 v[100:103], v[120:123], a[88:91], v[100:103]
  buffer_load_dwordx4 v30, s[12:15], s81 offen lds
  v_mfma_f32_16x16x32_bf16 v[104:107], v[120:123], a[92:95], v[104:107]
  s_waitcnt lgkmcnt(4)
  s_sub_u32 s51, s73, 1
  s_and_b32 s51, s51, 0x40000000
  v_mfma_f32_16x16x32_bf16 v[112:115], v[124:127], v[8:11], v[112:115]
  buffer_load_dwordx4 v31, s[12:15], s81 offen offset:1024 lds
  v_mfma_f32_16x16x32_bf16 v[92:95], v[124:127], a[96:99], v[92:95]
  s_or_b32 s72, s72, s51
  s_or_b32 s74, s74, s51
  v_mfma_f32_16x16x32_bf16 v[96:99], v[124:127], a[100:103], v[96:99]
  ds_read_b64_tr_b16 v[120:121], v52 offset:36864
  ds_read_b64_tr_b16 v[122:123], v52 offset:37376
  v_mfma_f32_16x16x32_bf16 v[100:103], v[124:127], a[104:107], v[100:103]
  s_bfe_u32 s81, s28, 0x4000c
  v_lshlrev_b32 v65, 4, v5
  v_lshl_add_u32 v65, v6, 3, v65
  v_mfma_f32_16x16x32_bf16 v[104:107], v[124:127], a[108:111], v[104:107]
L_pad2:
  s_cbranch_execz L_padback
  s_waitcnt lgkmcnt(4)
  v_xor_b32 v49, v4, v3
  v_and_b32 v49, 1, v49
  v_mfma_f32_16x16x32_bf16 v[112:115], v[128:131], v[8:11], v[112:115]
  s_lshl_b32 s81, s81, 16
  v_add_u32 v49, -1, v49
  v_and_b32 v56, v49, v8
  v_mfma_f32_16x16x32_bf16 v[92:95], v[128:131], a[112:115], v[92:95]
  s_add_u32 m0, s68, 90112
  v_and_b32 v57, v49, v8
  v_and_b32 v58, v49, v8
  v_mfma_f32_16x16x32_bf16 v[96:99], v[128:131], a[116:119], v[96:99]
  ds_read_b64_tr_b16 v[124:125], v52 offset:40960
  ds_read_b64_tr_b16 v[126:127], v52 offset:41472
  v_mfma_f32_16x16x32_bf16 v[100:103], v[128:131], a[120:123], v[100:103]
  buffer_load_dwordx4 v30, s[12:15], s81 offen lds
  v_mfma_f32_16x16x32_bf16 v[104:107], v[128:131], a[124:127], v[104:107]
  s_waitcnt lgkmcnt(4)
  v_and_b32 v59, v49, v8
  v_mfma_f32_16x16x32_bf16 v[112:115], v[116:119], v[8:11], v[112:115]
  v_mfma_f32_16x16x32_bf16 v[92:95], v[116:119], a[128:131], v[92:95]
  buffer_load_dwordx4 v31, s[12:15], s81 offen offset:1024 lds
  v_mfma_f32_16x16x32_bf16 v[96:99], v[116:119], a[132:135], v[96:99]
  ds_read_b64_tr_b16 v[128:129], v52 offset:45056
  ds_read_b64_tr_b16 v[130:131], v52 offset:45568
  v_mfma_f32_16x16x32_bf16 v[100:103], v[116:119], a[136:139], v[100:103]
  s_bfe_u32 s81, s28, 0x40010
  v_mfma_f32_16x16x32_bf16 v[104:107], v[116:119], a[140:143], v[104:107]
  s_waitcnt lgkmcnt(4)
  v_mfma_f32_16x16x32_bf16 v[112:115], v[120:123], v[8:11], v[112:115]
  s_lshl_b32 s81, s81, 16
  v_mfma_f32_16x16x32_bf16 v[92:95], v[120:123], a[144:147], v[92:95]
  v_mfma_f32_16x16x32_bf16 v[96:99], v[120:123], a[148:151], v[96:99]
  ds_read_b64_tr_b16 v[116:117], v52 offset:49152
  ds_read_b64_tr_b16 v[118:119], v52 offset:49664
  v_mfma_f32_16x16x32_bf16 v[100:103], v[120:123], a[152:155], v[100:103]
  s_add_u32 m0, s68, 98304
  v_mfma_f32_16x16x32_bf16 v[104:107], v[120:123], a[156:159], v[104:107]
  s_waitcnt lgkmcnt(4)
  v_mfma_f32_16x16x32_bf16 v[112:115], v[124:127], v[8:11], v[112:115]
  buffer_load_dwordx4 v30, s[12:15], s81 offen lds
  v_mfma_f32_16x16x32_bf16 v[92:95], v[124:127], a[160:163], v[92:95]
  buffer_load_dwordx4 v31, s[12:15], s81 offen offset:1024 lds
  v_mfma_f32_16x16x32_bf16 v[96:99], v[124:127], a[164:167], v[96:99]
  ds_read_b64_tr_b16 v[120:121], v52 offset:53248
  ds_read_b64_tr_b16 v[122:123], v52 offset:53760
  v_mfma_f32_16x16x32_bf16 v[100:103], v[124:127], a[168:171], v[100:103]
  s_bfe_u32 s81, s28, 0x40014
  v_mfma_f32_16x16x32_bf16 v[104:107], v[124:127], a[172:175], v[104:107]
  s_waitcnt lgkmcnt(4)
  v_mfma_f32_16x16x32_bf16 v[112:115], v[128:131], v[8:11], v[112:115]
  v_mfma_f32_16x16x32_bf16 v[92:95], v[128:131], a[176:179], v[92:95]
  s_lshl_b32 s81, s81, 16
  v_mfma_f32_16x16x32_bf16 v[96:99], v[128:131], a[180:183], v[96:99]
  ds_read_b64_tr_b16 v[124:125], v52 offset:57344
  ds_read_b64_tr_b16 v[126:127], v52 offset:57856
  v_mfma_f32_16x16x32_bf16 v[100:103], v[128:131], a[184:187], v[100:103]
  s_add_u32 m0, s68, 106496
  v_mfma_f32_16x16x32_bf16 v[104:107], v[128:131], a[188:191], v[104:107]
  s_waitcnt lgkmcnt(4)
  v_mfma_f32_16x16x32_bf16 v[112:115], v[116:119], v[8:11], v[112:115]
  buffer_load_dwordx4 v30, s[12:15], s81 offen lds
  v_mfma_f32_16x16x32_bf16 v[92:95], v[116:119], a[192:195], v[92:95]
  buffer_load_dwordx4 v31, s[12:15], s81 offen offset:1024 lds
  v_mfma_f32_16x16x32_bf16 v[96:99], v[116:119], a[196:199], v[96:99]
  ds_read_b64_tr_b16 v[128:129], v52 offset:61440
  ds_read_b64_tr_b16 v[130:131], v52 offset:61952
  v_mfma_f32_16x16x32_bf16 v[100:103], v[116:119], a[200:203], v[100:103]
  v_mfma_f32_16x16x32_bf16 v[104:107], v[116:119], a[204:207], v[104:107]
  s_waitcnt lgkmcnt(4)
  v_mfma_f32_16x16x32_bf16 v[112:115], v[120:123], v[8:11], v[112:115]
  s_bfe_u32 s81, s28, 0x40018
  v_mfma_f32_16x16x32_bf16 v[92:95], v[120:123], a[208:211], v[92:95]
  s_lshl_b32 s81, s81, 16
  v_mfma_f32_16x16x32_bf16 v[96:99], v[120:123], a[212:215], v[96:99]
  s_add_u32 m0, s68, 114688
  v_mfma_f32_16x16x32_bf16 v[100:103], v[120:123], a[216:219], v[100:103]
  v_mfma_f32_16x16x32_bf16 v[104:107], v[120:123], a[220:223], v[104:107]
  s_waitcnt lgkmcnt(2)
  v_mfma_f32_16x16x32_bf16 v[112:115], v[124:127], v[8:11], v[112:115]
  buffer_load_dwordx4 v30, s[12:15], s81 offen lds
  v_mfma_f32_16x16x32_bf16 v[92:95], v[124:127], a[224:227], v[92:95]
  buffer_load_dwordx4 v31, s[12:15], s81 offen offset:1024 lds
  v_mfma_f32_16x16x32_bf16 v[96:99], v[124:127], a[228:231], v[96:99]
  s_bfe_u32 s81, s28, 0x4001c
  v_mfma_f32_16x16x32_bf16 v[100:103], v[124:127], a[232:235], v[100:103]
  s_lshl_b32 s81, s81, 16
  v_mfma_f32_16x16x32_bf16 v[104:107], v[124:127], a[236:239], v[104:107]
  s_waitcnt lgkmcnt(0)
  v_mfma_f32_16x16x32_bf16 v[112:115], v[128:131], v[8:11], v[112:115]
  buffer_load_dwordx4 v[68:71], v2, s[36:39], s72 offen offset:0 sc1
  buffer_load_dwordx4 v[72:75], v2, s[36:39], s72 offen offset:1024 sc1
  v_mfma_f32_16x16x32_bf16 v[92:95], v[128:131], a[240:243], v[92:95]
  s_add_u32 m0, s68, 122880
  v_mfma_f32_16x16x32_bf16 v[96:99], v[128:131], a[244:247], v[96:99]
  buffer_load_dwordx4 v30, s[12:15], s81 offen lds
  v_mfma_f32_16x16x32_bf16 v[100:103], v[128:131], a[248:251], v[100:103]
  buffer_load_dwordx4 v31, s[12:15], s81 offen offset:1024 lds
  v_mfma_f32_16x16x32_bf16 v[104:107], v[128:131], a[252:255], v[104:107]
  s_add_u32 s56, s3, s40
  s_add_u32 s56, s56, 16384
  s_mov_b32 s62, s55
  s_barrier
  s_bfe_u32 s81, s28, 0x40000
  s_mul_i32 s81, s81, 176128
  s_add_u32 m0, s69, 0
  s_nop 0
  buffer_load_dwordx4 v27, s[16:19], s81 offen offset:0 lds
  v_pk_fma_f32 v[92:93], v[92:93], v[188:189], s[64:65] op_sel_hi:[1,0,1]
  v_pk_fma_f32 v[92:93], v[188:189], v[112:113], v[92:93] op_sel:[1,0,0] neg_lo:[1,0,0] neg_hi:[1,0,0]
  v_pk_mul_f32 v[220:221], v[92:93], s[66:67]
  v_max_f32 v92, s64, v92
  v_exp_f32_e64 v220, v220 clamp
  v_exp_f32_e64 v221, v221 clamp
  v_max_f32 v93, s64, v93
  v_pk_add_f32 v[92:93], v[92:93], v[220:221]
  v_cvt_pk_bf16_f32 v212, v92, v93
  v_pk_fma_f32 v[94:95], v[94:95], v[188:189], s[64:65] op_sel_hi:[1,0,1]
  v_pk_fma_f32 v[94:95], v[188:189], v[114:115], v[94:95] op_sel:[1,0,0] neg_lo:[1,0,0] neg_hi:[1,0,0]
  v_pk_mul_f32 v[220:221], v[94:95], s[66:67]
  v_max_f32 v94, s64, v94
  v_exp_f32_e64 v220, v220 clamp
  v_exp_f32_e64 v221, v221 clamp
  v_max_f32 v95, s64, v95
  v_pk_add_f32 v[94:95], v[94:95], v[220:221]
  v_cvt_pk_bf16_f32 v213, v94, v95
  v_pk_fma_f32 v[96:97], v[96:97], v[190:191], s[64:65] op_sel_hi:[1,0,1]
  v_pk_fma_f32 v[96:97], v[190:191], v[112:113], v[96:97] op_sel:[1,0,0] neg_lo:[1,0,0] neg_hi:[1,0,0]
  v_pk_mul_f32 v[220:221], v[96:97], s[66:67]
  v_max_f32 v96, s64, v96
  v_exp_f32_e64 v220, v220 clamp
  v_exp_f32_e64 v221, v221 clamp
  v_max_f32 v97, s64, v97
  v_pk_add_f32 v[96:97], v[96:97], v[220:221]
  v_cvt_pk_bf16_f32 v214, v96, v97
  v_pk_fma_f32 v[98:99], v[98:99], v[190:191], s[64:65] op_sel_hi:[1,0,1]
  v_pk_fma_f32 v[98:99], v[190:191], v[114:115], v[98:99] op_sel:[1,0,0] neg_lo:[1,0,0] neg_hi:[1,0,0]
  v_pk_mul_f32 v[220:221], v[98:99], s[66:67]
  v_max_f32 v98, s64, v98
  v_exp_f32_e64 v220, v220 clamp
  v_exp_f32_e64 v221, v221 clamp
  v_max_f32 v99, s64, v99
  v_pk_add_f32 v[98:99], v[98:99], v[220:221]
  v_cvt_pk_bf16_f32 v215, v98, v99
  v_permlane16_swap_b32 v212, v214
  s_nop 0
  v_permlane16_swap_b32 v213, v215
  v_pk_fma_f32 v[100:101], v[100:101], v[192:193], s[64:65] op_sel_hi:[1,0,1]
  v_pk_fma_f32 v[100:101], v[192:193], v[112:113], v[100:101] op_sel:[1,0,0] neg_lo:[1,0,0] neg_hi:[1,0,0]
  v_pk_mul_f32 v[220:221], v[100:101], s[66:67]
  v_max_f32 v100, s64, v100
  v_exp_f32_e64 v220, v220 clamp
  v_exp_f32_e64 v221, v221 clamp
  v_max_f32 v101, s64, v101
  v_pk_add_f32 v[100:101], v[100:101], v[220:221]
  v_cvt_pk_bf16_f32 v216, v100, v101
  v_pk_fma_f32 v[102:103], v[102:103], v[192:193], s[64:65] op_sel_hi:[1,0,1]
  v_pk_fma_f32 v[102:103], v[192:193], v[114:115], v[102:103] op_sel:[1,0,0] neg_lo:[1,0,0] neg_hi:[1,0,0]
  v_pk_mul_f32 v[220:221], v[102:103], s[66:67]
  v_max_f32 v102, s64, v102
  v_exp_f32_e64 v220, v220 clamp
  v_exp_f32_e64 v221, v221 clamp
  v_max_f32 v103, s64, v103
  v_pk_add_f32 v[102:103], v[102:103], v[220:221]
  v_cvt_pk_bf16_f32 v217, v102, v103
  v_pk_fma_f32 v[104:105], v[104:105], v[194:195], s[64:65] op_sel_hi:[1,0,1]
  v_pk_fma_f32 v[104:105], v[194:195], v[112:113], v[104:105] op_sel:[1,0,0] neg_lo:[1,0,0] neg_hi:[1,0,0]
  v_pk_mul_f32 v[220:221], v[104:105], s[66:67]
  v_max_f32 v104, s64, v104
  v_exp_f32_e64 v220, v220 clamp
  v_exp_f32_e64 v221, v221 clamp
  v_max_f32 v105, s64, v105
  v_pk_add_f32 v[104:105], v[104:105], v[220:221]
  v_cvt_pk_bf16_f32 v218, v104, v105
  v_pk_fma_f32 v[106:107], v[106:107], v[194:195], s[64:65] op_sel_hi:[1,0,1]
  v_pk_fma_f32 v[106:107], v[194:195], v[114:115], v[106:107] op_sel:[1,0,0] neg_lo:[1,0,0] neg_hi:[1,0,0]
  v_pk_mul_f32 v[220:221], v[106:107], s[66:67]
  v_max_f32 v106, s64, v106
  v_exp_f32_e64 v220, v220 clamp
  v_exp_f32_e64 v221, v221 clamp
  v_max_f32 v107, s64, v107
  v_pk_add_f32 v[106:107], v[106:107], v[220:221]
  v_cvt_pk_bf16_f32 v219, v106, v107
  v_permlane16_swap_b32 v216, v218
  s_nop 0
  v_permlane16_swap_b32 v217, v219
  buffer_store_dwordx4 v[212:215], v2, s[36:39], s56 offen offset:0 sc1
  buffer_store_dwordx4 v[216:219], v2, s[36:39], s56 offen offset:1024 sc1
  s_cmp_eq_u32 s73, 0
  s_cbranch_scc1 L_r1
  s_mov_b32 s55, 0
  s_waitcnt vmcnt(5)
  s_branch L_rc3
L_rp2:
  buffer_load_dwordx4 v[68:71], v2, s[36:39], s72 offen offset:0 sc1
  buffer_load_dwordx4 v[72:75], v2, s[36:39], s72 offen offset:1024 sc1
  s_add_u32 s55, s55, 1
  s_waitcnt vmcnt(0)
L_rc3:
  v_xor_b32 v68, v68, v224
  v_xor_b32 v69, v69, v225
  v_xor_b32 v70, v70, v226
  v_xor_b32 v71, v71, v227
  v_xor_b32 v72, v72, v224
  v_xor_b32 v73, v73, v225
  v_xor_b32 v74, v74, v226
  v_xor_b32 v75, v75, v227
  v_or3_b32 v76, v68, v69, v70
  v_or3_b32 v77, v71, v72, v73
  v_or3_b32 v76, v76, v74, v75
  v_bitop3_b32 v76, v76, v77, s79 bitop3:0x54
  v_cmp_ne_u32 vcc, 0, v76
  s_cmp_gt_u32 s55, 0x40000
  s_cbranch_scc1 L_rpo4
  s_cbranch_vccnz L_rp2
L_rpo4:
  v_pk_add_f32 v[68:69], v[68:69], v[72:73]
  v_pk_add_f32 v[70:71], v[70:71], v[74:75]
  s_mov_b32 s73, 0
  s_nop 0
  v_permlane32_swap_b32 v68, v70
  v_permlane32_swap_b32 v69, v71
  v_pk_add_f32 v[68:69], v[68:69], v[70:71]
  s_nop 1
  v_add_f32_dpp v70, v68, v68 row_ror:8 row_mask:0xf bank_mask:0xf
  v_add_f32_dpp v71, v69, v69 row_ror:8 row_mask:0xf bank_mask:0xf
  s_nop 0
  v_add_f32_dpp v68, v70, v70 row_ror:4 row_mask:0xf bank_mask:0xf
  v_add_f32_dpp v69, v71, v71 row_ror:4 row_mask:0xf bank_mask:0xf
  v_mov_b64 v[70:71], v[68:69]
  s_nop 1
  v_permlane16_swap_b32 v68, v70
  v_permlane16_swap_b32 v69, v71
  v_pk_add_f32 v[68:69], v[68:69], v[70:71]
  v_cvt_pk_bf16_f32 v68, v68, v69
  v_mov_b32 v69, v12
L_r1:
  s_mov_b32 exec_lo, 15
  s_mov_b32 exec_hi, 15
  buffer_store_dwordx2 v[68:69], v65, s[36:39], s74 offen sc1
  s_mov_b64 exec, -1
  s_add_u32 s51, s68, 148480
  v_add_u32 v14, s51, v2
  ds_write_b128 v14, v[212:215] offset:0
  ds_write_b128 v14, v[216:219] offset:1024
  s_lshl_b32 s49, s48, 12
  buffer_load_dwordx4 v28, s[16:19], s81 offen offset:1024 lds
  s_lshl_b32 s50, s47, 10
  s_add_u32 s49, s49, s50
  s_add_u32 s50, s49, 148480
  v_add_u32 v62, s50, v2
  s_add_u32 s49, s49, s40
  buffer_load_dwordx4 v29, s[16:19], s81 offen offset:2048 lds
  s_add_u32 s49, s49, 16384
  v_add_u32 v61, s49, v2
  v_lshlrev_b32 v168, 16, v16
  v_and_b32 v169, s80, v16
  v_lshlrev_b32 v170, 16, v17
  s_add_u32 s81, s81, 88064
  s_add_u32 m0, s69, 12288
  s_nop 0
  buffer_load_dwordx4 v27, s[16:19], s81 offen offset:0 lds
  v_and_b32 v171, s80, v17
  v_lshlrev_b32 v172, 16, v18
  v_and_b32 v173, s80, v18
  v_lshlrev_b32 v174, 16, v19
  v_and_b32 v175, s80, v19
  v_lshlrev_b32 v176, 16, v20
  buffer_load_dwordx4 v28, s[16:19], s81 offen offset:1024 lds
  v_and_b32 v177, s80, v20
  v_lshlrev_b32 v178, 16, v21
  v_and_b32 v179, s80, v21
  v_lshlrev_b32 v180, 16, v22
  v_and_b32 v181, s80, v22
  buffer_load_dwordx4 v29, s[16:19], s81 offen offset:2048 lds
  v_lshlrev_b32 v182, 16, v23
  v_and_b32 v183, s80, v23
  v_mov_b64 v[200:201], s[64:65]
  v_mov_b64 v[202:203], s[64:65]
  v_mov_b64 v[204:205], s[64:65]
  s_bfe_u32 s81, s28, 0x40004
  s_mul_i32 s81, s81, 176128
  s_add_u32 m0, s69, 24576
  s_nop 0
  buffer_load_dwordx4 v27, s[16:19], s81 offen offset:0 lds
  v_mov_b64 v[206:207], s[64:65]
  v_mov_b64 v[208:209], 0
  v_mov_b64 v[210:211], 0
  v_mov_b64 v[212:213], 0
  v_mov_b64 v[214:215], 0
  s_lshl_b32 s49, s44, 13
  s_lshl1_add_u32 s72, s46, s44
  s_add_u32 s73, s72, 1
  s_and_b32 s72, s72, 7
  s_lshl_b32 s72, s72, 12
  s_add_u32 s72, s72, 32768
  s_and_b32 s73, s73, 7
  s_lshl_b32 s73, s73, 12
  s_add_u32 s73, s73, 32768
  s_mov_b32 s74, 65536
  s_mov_b32 s100, 1
  s_mov_b64 exec, 0
  s_cmp_eq_u32 s46, 1
  s_cbranch_scc1 L_pad4
  s_cmp_eq_u32 s46, 2
  s_cbranch_scc1 L_pad5
  s_cmp_eq_u32 s46, 3
  s_cbranch_scc1 L_pad6
L_padback2:
  s_mov_b64 exec, -1
  s_waitcnt vmcnt(7) lgkmcnt(0)
  s_barrier
  s_add_u32 s3, s41, 0
  s_mov_b64 exec, 15
  buffer_store_dword v244, v13, s[36:39], s3 offen
  s_mov_b64 exec, -1
  ds_read_b128 v[64:67], v62 offset:0
  ds_read_b128 v[68:71], v62 offset:2048
  ds_read_b64_tr_b16 a[48:49], v42 offset:0
  buffer_load_dwordx4 v28, s[16:19], s81 offen offset:1024 lds
  ds_read_b64_tr_b16 a[50:51], v42 offset:1024
  ds_read_b64_tr_b16 a[176:177], v43 offset:0
  ds_read_b64_tr_b16 a[178:179], v43 offset:1024
  ds_read_b64_tr_b16 a[52:53], v42 offset:2048
  ds_read_b64_tr_b16 a[54:55], v42 offset:3072
  ds_read_b64_tr_b16 a[180:181], v43 offset:2048
  ds_read_b64_tr_b16 a[182:183], v43 offset:3072
  ds_read_b64_tr_b16 a[56:57], v42 offset:8192
  buffer_load_dwordx4 v29, s[16:19], s81 offen offset:2048 lds
  ds_read_b64_tr_b16 a[58:59], v42 offset:9216
  ds_read_b64_tr_b16 a[184:185], v43 offset:8192
  ds_read_b64_tr_b16 a[186:187], v43 offset:9216
  ds_read_b64_tr_b16 a[60:61], v42 offset:10240
  ds_read_b64_tr_b16 a[62:63], v42 offset:11264
  ds_read_b64_tr_b16 a[188:189], v43 offset:10240
  ds_read_b64_tr_b16 a[190:191], v43 offset:11264
  ds_read_b64_tr_b16 a[64:65], v42 offset:16384
  s_add_u32 s81, s81, 88064
  s_add_u32 m0, s69, 36864
  s_nop 0
  buffer_load_dwordx4 v27, s[16:19], s81 offen offset:0 lds
  ds_read_b64_tr_b16 a[66:67], v42 offset:17408
  ds_read_b64_tr_b16 a[192:193], v43 offset:16384
  ds_read_b64_tr_b16 a[194:195], v43 offset:17408
  ds_read_b64_tr_b16 a[68:69], v42 offset:18432
  ds_read_b64_tr_b16 a[70:71], v42 offset:19456
  ds_read_b64_tr_b16 a[196:197], v43 offset:18432
  ds_read_b64_tr_b16 a[198:199], v43 offset:19456
  ds_read_b64_tr_b16 a[72:73], v42 offset:24576
  buffer_load_dwordx4 v28, s[16:19], s81 offen offset:1024 lds
  ds_read_b64_tr_b16 a[74:75], v42 offset:25600
  ds_read_b64_tr_b16 a[200:201], v43 offset:24576
  ds_read_b64_tr_b16 a[202:203], v43 offset:25600
  ds_read_b64_tr_b16 a[76:77], v42 offset:26624
  ds_read_b64_tr_b16 a[78:79], v42 offset:27648
  ds_read_b64_tr_b16 a[204:205], v43 offset:26624
  ds_read_b64_tr_b16 a[206:207], v43 offset:27648
  ds_read_b64_tr_b16 a[80:81], v42 offset:32768
  buffer_load_dwordx4 v29, s[16:19], s81 offen offset:2048 lds
  ds_read_b64_tr_b16 a[82:83], v42 offset:33792
  ds_read_b64_tr_b16 a[208:209], v43 offset:32768
  ds_read_b64_tr_b16 a[210:211], v43 offset:33792
  ds_read_b64_tr_b16 a[84:85], v42 offset:34816
  ds_read_b64_tr_b16 a[86:87], v42 offset:35840
  ds_read_b64_tr_b16 a[212:213], v43 offset:34816
  ds_read_b64_tr_b16 a[214:215], v43 offset:35840
  ds_read_b64_tr_b16 a[88:89], v42 offset:40960
  s_bfe_u32 s81, s28, 0x40008
  s_mul_i32 s81, s81, 176128
  s_add_u32 m0, s69, 49152
  s_nop 0
  buffer_load_dwordx4 v27, s[16:19], s81 offen offset:0 lds
  ds_read_b64_tr_b16 a[90:91], v42 offset:41984
  ds_read_b64_tr_b16 a[216:217], v43 offset:40960
  ds_read_b64_tr_b16 a[218:219], v43 offset:41984
  ds_read_b64_tr_b16 a[92:93], v42 offset:43008
  ds_read_b64_tr_b16 a[94:95], v42 offset:44032
  ds_read_b64_tr_b16 a[220:221], v43 offset:43008
  ds_read_b64_tr_b16 a[222:223], v43 offset:44032
  ds_read_b64_tr_b16 a[96:97], v42 offset:49152
  buffer_load_dwordx4 v28, s[16:19], s81 offen offset:1024 lds
  ds_read_b64_tr_b16 a[98:99], v42 offset:50176
  ds_read_b64_tr_b16 a[224:225], v43 offset:49152
  ds_read_b64_tr_b16 a[226:227], v43 offset:50176
  ds_read_b64_tr_b16 a[100:101], v42 offset:51200
  ds_read_b64_tr_b16 a[102:103], v42 offset:52224
  ds_read_b64_tr_b16 a[228:229], v43 offset:51200
  ds_read_b64_tr_b16 a[230:231], v43 offset:52224
  ds_read_b64_tr_b16 a[104:105], v42 offset:57344
  buffer_load_dwordx4 v29, s[16:19], s81 offen offset:2048 lds
  ds_read_b64_tr_b16 a[106:107], v42 offset:58368
  ds_read_b64_tr_b16 a[232:233], v43 offset:57344
  ds_read_b64_tr_b16 a[234:235], v43 offset:58368
  ds_read_b64_tr_b16 a[108:109], v42 offset:59392
  ds_read_b64_tr_b16 a[110:111], v42 offset:60416
  ds_read_b64_tr_b16 a[236:237], v43 offset:59392
  ds_read_b64_tr_b16 a[238:239], v43 offset:60416
  s_add_u32 s71, s40, 0
  s_mov_b32 s55, 0
L_sp5:
  s_load_dwordx8 s[84:91], s[36:37], s71
  s_add_u32 s71, s71, 64
  s_add_u32 s55, s55, 1
  s_cmp_gt_u32 s55, 16
  s_cbranch_scc1 L_pc8
  s_waitcnt lgkmcnt(0)
  s_xor_b64 s[84:85], s[84:85], s[0:1]
  s_xor_b64 s[86:87], s[86:87], s[0:1]
  s_xor_b64 s[88:89], s[88:89], s[0:1]
  s_xor_b64 s[90:91], s[90:91], s[0:1]
  s_or_b64 s[84:85], s[84:85], s[88:89]
  s_or_b64 s[86:87], s[86:87], s[90:91]
  s_or_b64 s[84:85], s[84:85], s[86:87]
  s_cbranch_scc1 L_sp5
L_pollo7:
  s_add_u32 s49, s49, 8192
  s_and_b32 s49, s49, 0xffff
  buffer_load_dwordx4 v[72:75], v61, s[36:39], s49 offen offset:0 sc1
  buffer_load_dwordx4 v[76:79], v61, s[36:39], s49 offen offset:2048 sc1
  buffer_load_dwordx4 v[128:131], v2, s[36:39], s72 offen offset:0 sc1
  buffer_load_dwordx4 v[132:135], v2, s[36:39], s72 offen offset:1024 sc1
  s_waitcnt vmcnt(4)
  s_barrier
  buffer_load_dwordx4 v[136:139], v2, s[36:39], s72 offen offset:2048 sc1
  ds_read_b64_tr_b16 a[0:1], v32 offset:0
  ds_read_b64_tr_b16 a[2:3], v32 offset:3072
  ds_read_b64_tr_b16 a[128:129], v33 offset:0
  ds_read_b64_tr_b16 a[130:131], v33 offset:3072
  ds_read_b64_tr_b16 a[4:5], v32 offset:6144
  ds_read_b64_tr_b16 a[6:7], v32 offset:9216
  buffer_load_dwordx4 v[140:143], v2, s[36:39], s72 offen offset:3072 sc1
  ds_read_b64_tr_b16 a[132:133], v33 offset:6144
  ds_read_b64_tr_b16 a[134:135], v33 offset:9216
  s_waitcnt lgkmcnt(6)
  v_mfma_f32_16x16x32_bf16 v[48:51], v[56:59], a[0:3], 0
  ds_read_b64_tr_b16 a[8:9], v32 offset:12288
  ds_read_b64_tr_b16 a[10:11], v32 offset:15360
  buffer_load_dwordx4 v[144:147], v2, s[36:39], s73 offen offset:0 sc1
  s_waitcnt lgkmcnt(6)
  v_mfma_f32_16x16x32_bf16 v[52:55], v[56:59], a[128:131], 0
  ds_read_b64_tr_b16 a[136:137], v33 offset:12288
  ds_read_b64_tr_b16 a[138:139], v33 offset:15360
  s_waitcnt lgkmcnt(6)
  v_mfma_f32_16x16x32_bf16 v[48:51], v[56:59], a[4:7], v[48:51]
  ds_read_b64_tr_b16 a[12:13], v32 offset:18432
  ds_read_b64_tr_b16 a[14:15], v32 offset:21504
  buffer_load_dwordx4 v[148:151], v2, s[36:39], s73 offen offset:1024 sc1
  s_waitcnt lgkmcnt(6)
  v_mfma_f32_16x16x32_bf16 v[52:55], v[56:59], a[132:135], v[52:55]
  ds_read_b64_tr_b16 a[140:141], v33 offset:18432
  ds_read_b64_tr_b16 a[142:143], v33 offset:21504
  s_waitcnt lgkmcnt(6)
  v_mfma_f32_16x16x32_bf16 v[48:51], v[56:59], a[8:11], v[48:51]
  ds_read_b64_tr_b16 a[16:17], v32 offset:24576
  buffer_load_dwordx4 v[152:155], v2, s[36:39], s73 offen offset:2048 sc1
  ds_read_b64_tr_b16 a[18:19], v32 offset:27648
  s_waitcnt lgkmcnt(6)
  v_mfma_f32_16x16x32_bf16 v[52:55], v[56:59], a[136:139], v[52:55]
  ds_read_b64_tr_b16 a[144:145], v33 offset:24576
  ds_read_b64_tr_b16 a[146:147], v33 offset:27648
  s_waitcnt lgkmcnt(6)
  v_mfma_f32_16x16x32_bf16 v[48:51], v[56:59], a[12:15], v[48:51]
  ds_read_b64_tr_b16 a[20:21], v32 offset:30720
  buffer_load_dwordx4 v[156:159], v2, s[36:39], s73 offen offset:3072 sc1
  ds_read_b64_tr_b16 a[22:23], v32 offset:33792
  s_waitcnt lgkmcnt(6)
  v_mfma_f32_16x16x32_bf16 v[52:55], v[56:59], a[140:143], v[52:55]
  ds_read_b64_tr_b16 a[148:149], v33 offset:30720
  ds_read_b64_tr_b16 a[150:151], v33 offset:33792
  s_waitcnt lgkmcnt(6)
  v_mfma_f32_16x16x32_bf16 v[48:51], v[56:59], a[16:19], v[48:51]
  buffer_load_dwordx4 v[160:163], v40, s[36:39], s74 offen sc1
  ds_read_b64_tr_b16 a[24:25], v32 offset:36864
  ds_read_b64_tr_b16 a[26:27], v32 offset:39936
  s_waitcnt lgkmcnt(6)
  v_mfma_f32_16x16x32_bf16 v[52:55], v[56:59], a[144:147], v[52:55]
  ds_read_b64_tr_b16 a[152:153], v33 offset:36864
  ds_read_b64_tr_b16 a[154:155], v33 offset:39936
  s_waitcnt lgkmcnt(6)
  v_mfma_f32_16x16x32_bf16 v[48:51], v[56:59], a[20:23], v[48:51]
  s_add_u32 s49, s49, 8192
  s_and_b32 s49, s49, 0xffff
  buffer_load_dwordx4 v[80:83], v61, s[36:39], s49 offen offset:0 sc1
  ds_read_b64_tr_b16 a[28:29], v32 offset:43008
  ds_read_b64_tr_b16 a[30:31], v32 offset:46080
  s_waitcnt lgkmcnt(6)
  v_mfma_f32_16x16x32_bf16 v[52:55], v[56:59], a[148:151], v[52:55]
  ds_read_b64_tr_b16 a[156:157], v33 offset:43008
  ds_read_b64_tr_b16 a[158:159], v33 offset:46080
  buffer_load_dwordx4 v[84:87], v61, s[36:39], s49 offen offset:2048 sc1
  s_waitcnt lgkmcnt(6)
  v_mfma_f32_16x16x32_bf16 v[48:51], v[56:59], a[24:27], v[48:51]
  ds_read_b64_tr_b16 a[32:33], v32 offset:49152
  ds_read_b64_tr_b16 a[34:35], v32 offset:52224
  s_waitcnt lgkmcnt(6)
  v_mfma_f32_16x16x32_bf16 v[52:55], v[56:59], a[152:155], v[52:55]
  ds_read_b64_tr_b16 a[160:161], v33 offset:49152
  ds_read_b64_tr_b16 a[162:163], v33 offset:52224
  s_add_u32 s49, s49, 8192
  s_and_b32 s49, s49, 0xffff
  buffer_load_dwordx4 v[88:91], v61, s[36:39], s49 offen offset:0 sc1
  s_waitcnt lgkmcnt(6)
  v_mfma_f32_16x16x32_bf16 v[48:51], v[56:59], a[28:31], v[48:51]
  ds_read_b64_tr_b16 a[36:37], v32 offset:55296
  ds_read_b64_tr_b16 a[38:39], v32 offset:58368
  s_waitcnt lgkmcnt(6)
  v_mfma_f32_16x16x32_bf16 v[52:55], v[56:59], a[156:159], v[52:55]
  ds_read_b64_tr_b16 a[164:165], v33 offset:55296
  buffer_load_dwordx4 v[92:95], v61, s[36:39], s49 offen offset:2048 sc1
  ds_read_b64_tr_b16 a[166:167], v33 offset:58368
  s_waitcnt lgkmcnt(6)
  v_mfma_f32_16x16x32_bf16 v[48:51], v[56:59], a[32:35], v[48:51]
  s_waitcnt lgkmcnt(4)
  v_mfma_f32_16x16x32_bf16 v[52:55], v[56:59], a[160:163], v[52:55]
  s_waitcnt lgkmcnt(2)
  v_mfma_f32_16x16x32_bf16 v[48:51], v[56:59], a[36:39], v[48:51]
  s_waitcnt lgkmcnt(0)
  v_mfma_f32_16x16x32_bf16 v[52:55], v[56:59], a[164:167], v[52:55]
  s_waitcnt vmcnt(12)
  v_xor_b32 v164, v129, v12
  v_mov_b32 v129, v130
  ds_write_b64 v38, v[128:129] offset:0
  v_bitop3_b32 v164, v164, v131, v12 bitop3:0xf6
  s_add_u32 s49, s49, 8192
  s_and_b32 s49, s49, 0xffff
  buffer_load_dwordx4 v[96:99], v61, s[36:39], s49 offen offset:0 sc1
  s_waitcnt vmcnt(12)
  v_bitop3_b32 v164, v164, v133, v12 bitop3:0xf6
  v_mov_b32 v133, v134
  ds_write_b64 v38, v[132:133] offset:544
  v_bitop3_b32 v164, v164, v135, v12 bitop3:0xf6
  buffer_load_dwordx4 v[100:103], v61, s[36:39], s49 offen offset:2048 sc1
  s_waitcnt vmcnt(12)
  v_bitop3_b32 v164, v164, v137, v12 bitop3:0xf6
  v_mov_b32 v137, v138
  ds_write_b64 v38, v[136:137] offset:1088
  v_bitop3_b32 v164, v164, v139, v12 bitop3:0xf6
  s_add_u32 s49, s49, 8192
  s_and_b32 s49, s49, 0xffff
  buffer_load_dwordx4 v[104:107], v61, s[36:39], s49 offen offset:0 sc1
  s_waitcnt vmcnt(12)
  v_bitop3_b32 v164, v164, v141, v12 bitop3:0xf6
  v_mov_b32 v141, v142
  ds_write_b64 v38, v[140:141] offset:1632
  v_bitop3_b32 v164, v164, v143, v12 bitop3:0xf6
  buffer_load_dwordx4 v[108:111], v61, s[36:39], s49 offen offset:2048 sc1
  s_waitcnt vmcnt(12)
  v_bitop3_b32 v164, v164, v145, v12 bitop3:0xf6
  v_mov_b32 v145, v146
  ds_write_b64 v38, v[144:145] offset:2176
  v_bitop3_b32 v164, v164, v147, v12 bitop3:0xf6
  s_waitcnt vmcnt(11)
  v_bitop3_b32 v164, v164, v149, v12 bitop3:0xf6
  v_mov_b32 v149, v150
  ds_write_b64 v38, v[148:149] offset:2720
  v_bitop3_b32 v164, v164, v151, v12 bitop3:0xf6
  s_add_u32 s49, s49, 8192
  s_and_b32 s49, s49, 0xffff
  buffer_load_dwordx4 v[112:115], v61, s[36:39], s49 offen offset:0 sc1
  s_waitcnt vmcnt(11)
  v_bitop3_b32 v164, v164, v153, v12 bitop3:0xf6
  v_mov_b32 v153, v154
  ds_write_b64 v38, v[152:153] offset:3264
  v_bitop3_b32 v164, v164, v155, v12 bitop3:0xf6
  buffer_load_dwordx4 v[116:119], v61, s[36:39], s49 offen offset:2048 sc1
  s_waitcnt vmcnt(11)
  v_bitop3_b32 v164, v164, v157, v12 bitop3:0xf6
  v_mov_b32 v157, v158
  ds_write_b64 v38, v[156:157] offset:3808
  v_bitop3_b32 v164, v164, v159, v12 bitop3:0xf6
  s_add_u32 s49, s49, 8192
  s_and_b32 s49, s49, 0xffff
  buffer_load_dwordx4 v[120:123], v61, s[36:39], s49 offen offset:0 sc1
  s_waitcnt vmcnt(11)
  v_bitop3_b32 v164, v164, v161, v12 bitop3:0xf6
  v_mov_b32 v161, v162
  ds_write_b64 v39, v[160:161] offset:512
  v_bitop3_b32 v164, v164, v163, v12 bitop3:0xf6
  v_cmp_ne_u32 vcc, 0, v164
  s_waitcnt lgkmcnt(0)
  s_mov_b32 s55, 0
  s_cbranch_vccnz L_gp11
L_gpo12:
  s_barrier
  ds_read_b128 v[216:219], v41 offset:0
  ds_read_b128 v[220:223], v41 offset:544
  ds_read_b128 v[224:227], v41 offset:2176
  s_waitcnt lgkmcnt(2)
  v_mfma_f32_32x32x16_bf16 v[128:143], v[216:219], v[64:67], v[200:215]
  s_waitcnt lgkmcnt(1)
  v_mfma_f32_32x32x16_bf16 v[144:159], v[220:223], v[68:71], v[200:215]
  s_waitcnt lgkmcnt(0)
  ds_read_b128 v[216:219], v41 offset:2720
  s_nop 7
  v_rcp_f32 v228, v128
  s_nop 0
  v_mul_f32 v232, v136, v228
  v_mul_f32 v233, v137, v228
  v_mul_f32 v234, v138, v228
  v_mul_f32 v235, v139, v228
  v_mul_f32 v236, v140, v228
  v_mul_f32 v237, v141, v228
  v_mul_f32 v238, v142, v228
  v_mul_f32 v239, v143, v228
  v_cvt_pk_bf16_f32 v160, v232, v233
  v_cvt_pk_bf16_f32 v161, v234, v235
  v_cvt_pk_bf16_f32 v162, v236, v237
  v_mfma_f32_32x32x16_bf16 v[128:143], v[224:227], v[72:75], v[200:215]
  s_waitcnt lgkmcnt(0)
  ds_read_b128 v[220:223], v41 offset:4352
  v_rcp_f32 v228, v144
  v_cvt_pk_bf16_f32 v163, v238, v239
  v_mul_f32 v232, v152, v228
  v_mul_f32 v233, v153, v228
  v_mfma_f32_32x32x16_bf16 v[184:199], a[176:179], v[160:163], 0
  buffer_load_dwordx4 v[124:127], v61, s[36:39], s49 offen offset:2048 sc1
  v_mul_f32 v234, v154, v228
  v_mul_f32 v235, v155, v228
  v_mul_f32 v236, v156, v228
  v_mul_f32 v237, v157, v228
  v_mul_f32 v238, v158, v228
  v_mfma_f32_32x32x16_bf16 v[168:183], a[48:51], v[160:163], v[168:183]
  v_lshlrev_b32 v14, 10, v1
  s_mov_b64 exec, 0x7ff
  buffer_load_dword v255, v14, s[24:27], s62 offen offset:384
  s_mov_b64 exec, -1
  s_add_u32 s81, s81, 88064
  v_mul_f32 v239, v159, v228
  v_cvt_pk_bf16_f32 v164, v232, v233
  v_cvt_pk_bf16_f32 v165, v234, v235
  v_cvt_pk_bf16_f32 v166, v236, v237
L_pad3:
  s_cbranch_execz L_padback
  v_mfma_f32_32x32x16_bf16 v[144:159], v[216:219], v[76:79], v[200:215]
  s_waitcnt vmcnt(12) lgkmcnt(0)
  ds_read_b128 v[224:227], v41 offset:4896
  v_rcp_f32 v228, v128
  v_cvt_pk_bf16_f32 v167, v238, v239
  v_mul_f32 v232, v136, v228
  v_mul_f32 v233, v137, v228
  v_mfma_f32_32x32x16_bf16 v[184:199], a[180:183], v[164:167], v[184:199]
  s_add_u32 m0, s69, 65536
  v_mul_f32 v234, v138, v228
  v_mul_f32 v235, v139, v228
  v_mul_f32 v236, v140, v228
  v_mul_f32 v237, v141, v228
  v_mul_f32 v238, v142, v228
  v_mfma_f32_32x32x16_bf16 v[168:183], a[52:55], v[164:167], v[168:183]
  buffer_load_dwordx4 v27, s[16:19], s81 offen offset:0 lds
  v_mul_f32 v239, v143, v228
  v_cvt_pk_bf16_f32 v160, v232, v233
  v_cvt_pk_bf16_f32 v161, v234, v235
  v_cvt_pk_bf16_f32 v162, v236, v237
  v_mfma_f32_32x32x16_bf16 v[128:143], v[220:223], v[80:83], v[200:215]
  s_waitcnt vmcnt(12) lgkmcnt(0)
  ds_read_b128 v[216:219], v41 offset:6528
  v_rcp_f32 v228, v144
  v_cvt_pk_bf16_f32 v163, v238, v239
  v_mul_f32 v232, v152, v228
  v_mul_f32 v233, v153, v228
  v_mfma_f32_32x32x16_bf16 v[184:199], a[184:187], v[160:163], v[184:199]
  buffer_load_dwordx4 v28, s[16:19], s81 offen offset:1024 lds
  buffer_load_dwordx4 v29, s[16:19], s81 offen offset:2048 lds
  v_mul_f32 v234, v154, v228
  v_mul_f32 v235, v155, v228
  v_mul_f32 v236, v156, v228
  v_mul_f32 v237, v157, v228
  v_mul_f32 v238, v158, v228
  v_mfma_f32_32x32x16_bf16 v[168:183], a[56:59], v[160:163], v[168:183]
  s_bfe_u32 s81, s28, 0x4000c
  v_mul_f32 v239, v159, v228
  v_cvt_pk_bf16_f32 v164, v232, v233
  v_cvt_pk_bf16_f32 v165, v234, v235
  v_cvt_pk_bf16_f32 v166, v236, v237
  v_mfma_f32_32x32x16_bf16 v[144:159], v[224:227], v[84:87], v[200:215]
  s_waitcnt vmcnt(13) lgkmcnt(0)
  ds_read_b128 v[220:223], v41 offset:7072
  v_rcp_f32 v228, v128
  v_cvt_pk_bf16_f32 v167, v238, v239
  v_mul_f32 v232, v136, v228
  v_mul_f32 v233, v137, v228
  v_mfma_f32_32x32x16_bf16 v[184:199], a[188:191], v[164:167], v[184:199]
  s_mul_i32 s81, s81, 176128
  v_mul_f32 v234, v138, v228
  v_mul_f32 v235, v139, v228
  v_mul_f32 v236, v140, v228
  v_mul_f32 v237, v141, v228
  v_mul_f32 v238, v142, v228
  v_mfma_f32_32x32x16_bf16 v[168:183], a[60:63], v[164:167], v[168:183]
  s_add_u32 m0, s69, 77824
  s_nop 0
  buffer_load_dwordx4 v27, s[16:19], s81 offen offset:0 lds
  v_mul_f32 v239, v143, v228
  v_cvt_pk_bf16_f32 v160, v232, v233
  v_cvt_pk_bf16_f32 v161, v234, v235
  v_cvt_pk_bf16_f32 v162, v236, v237
  v_mfma_f32_32x32x16_bf16 v[128:143], v[216:219], v[88:91], v[200:215]
  s_waitcnt vmcnt(13) lgkmcnt(0)
  ds_read_b128 v[224:227], v41 offset:8704
  v_rcp_f32 v228, v144
  v_cvt_pk_bf16_f32 v163, v238, v239
  v_mul_f32 v232, v152, v228
  v_mul_f32 v233, v153, v228
  v_mfma_f32_32x32x16_bf16 v[184:199], a[192:195], v[160:163], v[184:199]
  buffer_load_dwordx4 v28, s[16:19], s81 offen offset:1024 lds
  v_mul_f32 v234, v154, v228
  v_mul_f32 v235, v155, v228
  v_mul_f32 v236, v156, v228
  v_mul_f32 v237, v157, v228
  v_mul_f32 v238, v158, v228
  v_mfma_f32_32x32x16_bf16 v[168:183], a[64:67], v[160:163], v[168:183]
  buffer_load_dwordx4 v29, s[16:19], s81 offen offset:2048 lds
  v_mul_f32 v239, v159, v228
  v_cvt_pk_bf16_f32 v164, v232, v233
  v_cvt_pk_bf16_f32 v165, v234, v235
  v_cvt_pk_bf16_f32 v166, v236, v237
  v_mfma_f32_32x32x16_bf16 v[144:159], v[220:223], v[92:95], v[200:215]
  s_waitcnt vmcnt(14) lgkmcnt(0)
  ds_read_b128 v[216:219], v41 offset:9248
  v_rcp_f32 v228, v128
  v_cvt_pk_bf16_f32 v167, v238, v239
  v_mul_f32 v232, v136, v228
  v_mul_f32 v233, v137, v228
  v_mfma_f32_32x32x16_bf16 v[184:199], a[196:199], v[164:167], v[184:199]
  s_add_u32 s81, s81, 88064
  s_add_u32 m0, s69, 90112
  v_mul_f32 v234, v138, v228
  v_mul_f32 v235, v139, v228
  v_mul_f32 v236, v140, v228
  v_mul_f32 v237, v141, v228
  v_mul_f32 v238, v142, v228
  v_mfma_f32_32x32x16_bf16 v[168:183], a[68:71], v[164:167], v[168:183]
  buffer_load_dwordx4 v27, s[16:19], s81 offen offset:0 lds
  v_mul_f32 v239, v143, v228
  v_cvt_pk_bf16_f32 v160, v232, v233
  v_cvt_pk_bf16_f32 v161, v234, v235
  v_cvt_pk_bf16_f32 v162, v236, v237
  v_mfma_f32_32x32x16_bf16 v[128:143], v[224:227], v[96:99], v[200:215]
  s_waitcnt vmcnt(14) lgkmcnt(0)
  ds_read_b128 v[220:223], v41 offset:10880
  v_rcp_f32 v228, v144
  v_cvt_pk_bf16_f32 v163, v238, v239
  v_mul_f32 v232, v152, v228
  v_mul_f32 v233, v153, v228
  v_mfma_f32_32x32x16_bf16 v[184:199], a[200:203], v[160:163], v[184:199]
  buffer_load_dwordx4 v28, s[16:19], s81 offen offset:1024 lds
  v_mul_f32 v234, v154, v228
  v_mul_f32 v235, v155, v228
  v_mul_f32 v236, v156, v228
  v_mul_f32 v237, v157, v228
  v_mul_f32 v238, v158, v228
  v_mfma_f32_32x32x16_bf16 v[168:183], a[72:75], v[160:163], v[168:183]
  buffer_load_dwordx4 v29, s[16:19], s81 offen offset:2048 lds
  v_mul_f32 v239, v159, v228
  v_cvt_pk_bf16_f32 v164, v232, v233
  v_cvt_pk_bf16_f32 v165, v234, v235
  v_cvt_pk_bf16_f32 v166, v236, v237
  v_mfma_f32_32x32x16_bf16 v[144:159], v[216:219], v[100:103], v[200:215]
  s_waitcnt vmcnt(15) lgkmcnt(0)
  ds_read_b128 v[224:227], v41 offset:11424
  v_rcp_f32 v228, v128
  v_cvt_pk_bf16_f32 v167, v238, v239
  v_mul_f32 v232, v136, v228
  v_mul_f32 v233, v137, v228
  v_mfma_f32_32x32x16_bf16 v[184:199], a[204:207], v[164:167], v[184:199]
  s_bfe_u32 s81, s28, 0x40010
  s_mul_i32 s81, s81, 176128
  v_mul_f32 v234, v138, v228
  v_mul_f32 v235, v139, v228
  v_mul_f32 v236, v140, v228
  v_mul_f32 v237, v141, v228
  v_mul_f32 v238, v142, v228
  v_mfma_f32_32x32x16_bf16 v[168:183], a[76:79], v[164:167], v[168:183]
  s_add_u32 m0, s69, 102400
  v_mul_f32 v239, v143, v228
  v_cvt_pk_bf16_f32 v160, v232, v233
  v_cvt_pk_bf16_f32 v161, v234, v235
  v_cvt_pk_bf16_f32 v162, v236, v237
  v_mfma_f32_32x32x16_bf16 v[128:143], v[220:223], v[104:107], v[200:215]
  s_waitcnt vmcnt(14) lgkmcnt(0)
  ds_read_b128 v[216:219], v41 offset:13056
  v_rcp_f32 v228, v144
  v_cvt_pk_bf16_f32 v163, v238, v239
  v_mul_f32 v232, v152, v228
  v_mul_f32 v233, v153, v228
  v_mfma_f32_32x32x16_bf16 v[184:199], a[208:211], v[160:163], v[184:199]
  buffer_load_dwordx4 v27, s[16:19], s81 offen offset:0 lds
  v_mul_f32 v234, v154, v228
  v_mul_f32 v235, v155, v228
  v_mul_f32 v236, v156, v228
  v_mul_f32 v237, v157, v228
  v_mul_f32 v238, v158, v228
  v_mfma_f32_32x32x16_bf16 v[168:183], a[80:83], v[160:163], v[168:183]
  buffer_load_dwordx4 v28, s[16:19], s81 offen offset:1024 lds
  buffer_load_dwordx4 v29, s[16:19], s81 offen offset:2048 lds
  v_mul_f32 v239, v159, v228
  v_cvt_pk_bf16_f32 v164, v232, v233
  v_cvt_pk_bf16_f32 v165, v234, v235
  v_cvt_pk_bf16_f32 v166, v236, v237
  v_mfma_f32_32x32x16_bf16 v[144:159], v[224:227], v[108:111], v[200:215]
  s_waitcnt vmcnt(16) lgkmcnt(0)
  ds_read_b128 v[220:223], v41 offset:13600
  v_rcp_f32 v228, v128
  v_cvt_pk_bf16_f32 v167, v238, v239
  v_mul_f32 v232, v136, v228
  v_mul_f32 v233, v137, v228
  v_mfma_f32_32x32x16_bf16 v[184:199], a[212:215], v[164:167], v[184:199]
  s_add_u32 s81, s81, 88064
  v_mul_f32 v234, v138, v228
  v_mul_f32 v235, v139, v228
  v_mul_f32 v236, v140, v228
  v_mul_f32 v237, v141, v228
  v_mul_f32 v238, v142, v228
  v_mfma_f32_32x32x16_bf16 v[168:183], a[84:87], v[164:167], v[168:183]
  s_add_u32 m0, s69, 114688
  v_mul_f32 v239, v143, v228
  v_cvt_pk_bf16_f32 v160, v232, v233
  v_cvt_pk_bf16_f32 v161, v234, v235
  v_cvt_pk_bf16_f32 v162, v236, v237
  v_mfma_f32_32x32x16_bf16 v[128:143], v[216:219], v[112:115], v[200:215]
  s_waitcnt vmcnt(15) lgkmcnt(0)
  ds_read_b128 v[224:227], v41 offset:15232
  v_rcp_f32 v228, v144
  v_cvt_pk_bf16_f32 v163, v238, v239
  v_mul_f32 v232, v152, v228
  v_mul_f32 v233, v153, v228
  v_mfma_f32_32x32x16_bf16 v[184:199], a[216:219], v[160:163], v[184:199]
  buffer_load_dwordx4 v27, s[16:19], s81 offen offset:0 lds
  buffer_load_dwordx4 v28, s[16:19], s81 offen offset:1024 lds
  v_mul_f32 v234, v154, v228
  v_mul_f32 v235, v155, v228
  v_mul_f32 v236, v156, v228
  v_mul_f32 v237, v157, v228
  v_mul_f32 v238, v158, v228
  v_mfma_f32_32x32x16_bf16 v[168:183], a[88:91], v[160:163], v[168:183]
  buffer_load_dwordx4 v29, s[16:19], s81 offen offset:2048 lds
  v_mul_f32 v239, v159, v228
  v_cvt_pk_bf16_f32 v64, v232, v233
  v_cvt_pk_bf16_f32 v65, v234, v235
  v_cvt_pk_bf16_f32 v66, v236, v237
  v_mfma_f32_32x32x16_bf16 v[144:159], v[220:223], v[116:119], v[200:215]
  s_waitcnt vmcnt(17) lgkmcnt(0)
  ds_read_b128 v[216:219], v41 offset:15776
  v_rcp_f32 v228, v128
  v_cvt_pk_bf16_f32 v67, v238, v239
  v_mul_f32 v232, v136, v228
  v_mul_f32 v233, v137, v228
  v_mfma_f32_32x32x16_bf16 v[184:199], a[220:223], v[64:67], v[184:199]
  s_bfe_u32 s81, s28, 0x40014
  v_mul_f32 v234, v138, v228
  v_mul_f32 v235, v139, v228
  v_mul_f32 v236, v140, v228
  v_mul_f32 v237, v141, v228
  v_mul_f32 v238, v142, v228
  v_mul_f32 v239, v143, v228
  v_cvt_pk_bf16_f32 v68, v232, v233
  v_cvt_pk_bf16_f32 v69, v234, v235
  v_cvt_pk_bf16_f32 v70, v236, v237
  v_mfma_f32_32x32x16_bf16 v[128:143], v[224:227], v[120:123], v[200:215]
  s_waitcnt vmcnt(16) lgkmcnt(0)
  v_rcp_f32 v228, v144
  v_cvt_pk_bf16_f32 v71, v238, v239
  v_mul_f32 v232, v152, v228
  v_mul_f32 v233, v153, v228
  v_mfma_f32_32x32x16_bf16 v[184:199], a[224:227], v[68:71], v[184:199]
  s_mul_i32 s81, s81, 176128
  s_add_u32 m0, s69, 0
  v_mul_f32 v234, v154, v228
  v_mul_f32 v235, v155, v228
  v_mul_f32 v236, v156, v228
  v_mul_f32 v237, v157, v228
  v_mul_f32 v238, v158, v228
  v_mul_f32 v239, v159, v228
  v_cvt_pk_bf16_f32 v72, v232, v233
  v_cvt_pk_bf16_f32 v73, v234, v235
  v_cvt_pk_bf16_f32 v74, v236, v237
  v_mfma_f32_32x32x16_bf16 v[144:159], v[216:219], v[124:127], v[200:215]
  v_rcp_f32 v228, v128
  v_cvt_pk_bf16_f32 v75, v238, v239
  v_mul_f32 v232, v136, v228
  v_mul_f32 v233, v137, v228
  v_mfma_f32_32x32x16_bf16 v[184:199], a[228:231], v[72:75], v[184:199]
  buffer_load_dwordx4 v27, s[16:19], s81 offen offset:0 lds
  v_mul_f32 v234, v138, v228
  v_mul_f32 v235, v139, v228
  v_mul_f32 v236, v140, v228
  v_mul_f32 v237, v141, v228
  v_mul_f32 v238, v142, v228
  v_mul_f32 v239, v143, v228
  v_cvt_pk_bf16_f32 v76, v232, v233
  v_cvt_pk_bf16_f32 v77, v234, v235
  v_cvt_pk_bf16_f32 v78, v236, v237
  v_rcp_f32 v228, v144
  v_cvt_pk_bf16_f32 v79, v238, v239
  v_mul_f32 v232, v152, v228
  v_mul_f32 v233, v153, v228
  v_mfma_f32_32x32x16_bf16 v[184:199], a[232:235], v[76:79], v[184:199]
  buffer_load_dwordx4 v28, s[16:19], s81 offen offset:1024 lds
  v_mul_f32 v234, v154, v228
  v_mul_f32 v235, v155, v228
  v_mul_f32 v236, v156, v228
  v_mul_f32 v237, v157, v228
  v_mul_f32 v238, v158, v228
  v_mul_f32 v239, v159, v228
  v_cvt_pk_bf16_f32 v80, v232, v233
  v_cvt_pk_bf16_f32 v81, v234, v235
  v_cvt_pk_bf16_f32 v82, v236, v237
  v_cvt_pk_bf16_f32 v83, v238, v239
  s_nop 1
  v_mfma_f32_32x32x16_bf16 v[184:199], a[236:239], v[80:83], v[184:199]
  buffer_load_dwordx4 v29, s[16:19], s81 offen offset:2048 lds
  v_mfma_f32_32x32x16_bf16 v[168:183], a[92:95], v[64:67], v[168:183]
  s_lshl_b32 s49, s44, 1
  s_add_u32 s49, s49, s48
  s_lshl_b32 s50, s47, 5
  s_add_u32 s50, s50, s49
  s_add_u32 s49, s49, s50
  s_lshl_b32 s50, s50, 7
  s_lshl_b32 s49, s49, 10
  s_add_u32 s49, s49, s40
  s_add_u32 s50, s50, s40
  s_add_u32 s49, s49, 81920
  s_add_u32 s50, s50, 344064
  ds_write_b128 v44, v[184:187] offset:0
  v_mfma_f32_32x32x16_bf16 v[168:183], a[96:99], v[68:71], v[168:183]
  ds_write_b128 v44, v[188:191] offset:1024
  v_mfma_f32_32x32x16_bf16 v[168:183], a[100:103], v[72:75], v[168:183]
  ds_write_b128 v44, v[192:195] offset:2048
  v_mfma_f32_32x32x16_bf16 v[168:183], a[104:107], v[76:79], v[168:183]
  ds_write_b128 v44, v[196:199] offset:3072
  v_mfma_f32_32x32x16_bf16 v[168:183], a[108:111], v[80:83], v[168:183]
  s_waitcnt vmcnt(9) lgkmcnt(0)
  s_barrier
  ds_read_b128 v[128:131], v45 offset:0
  ds_read_b128 v[132:135], v45 offset:1024
  ds_read_b128 v[136:139], v45 offset:2048
  ds_read_b128 v[140:143], v45 offset:3072
  s_waitcnt lgkmcnt(3)
  s_nop 4
  v_pk_add_f32 v[168:169], v[168:169], v[128:129]
  v_cvt_pk_bf16_f32 v232, v168, v169
  v_pk_add_f32 v[170:171], v[170:171], v[130:131]
  v_cvt_pk_bf16_f32 v233, v170, v171
  s_waitcnt lgkmcnt(2)
  v_pk_add_f32 v[172:173], v[172:173], v[132:133]
  v_cvt_pk_bf16_f32 v234, v172, v173
  v_pk_add_f32 v[174:175], v[174:175], v[134:135]
  v_cvt_pk_bf16_f32 v235, v174, v175
  buffer_store_dwordx4 v[232:235], v2, s[36:39], s49 offen offset:0 sc1
  s_waitcnt lgkmcnt(1)
  v_pk_add_f32 v[176:177], v[176:177], v[136:137]
  v_cvt_pk_bf16_f32 v236, v176, v177
  v_pk_add_f32 v[178:179], v[178:179], v[138:139]
  v_cvt_pk_bf16_f32 v237, v178, v179
  s_waitcnt lgkmcnt(0)
  v_pk_add_f32 v[180:181], v[180:181], v[140:141]
  v_cvt_pk_bf16_f32 v238, v180, v181
  v_pk_add_f32 v[182:183], v[182:183], v[142:143]
  v_cvt_pk_bf16_f32 v239, v182, v183
  buffer_store_dwordx4 v[236:239], v2, s[36:39], s49 offen offset:1024 sc1
  v_dot2_f32_bf16 v228, v232, v8, 0
  v_dot2_f32_bf16 v229, v232, v232, 0
  v_dot2_f32_bf16 v228, v233, v8, v228
  v_dot2_f32_bf16 v229, v233, v233, v229
  v_dot2_f32_bf16 v228, v234, v8, v228
  v_dot2_f32_bf16 v229, v234, v234, v229
  v_dot2_f32_bf16 v228, v235, v8, v228
  v_dot2_f32_bf16 v229, v235, v235, v229
  v_dot2_f32_bf16 v228, v236, v8, v228
  v_dot2_f32_bf16 v229, v236, v236, v229
  v_dot2_f32_bf16 v228, v237, v8, v228
  v_dot2_f32_bf16 v229, v237, v237, v229
  v_dot2_f32_bf16 v228, v238, v8, v228
  v_dot2_f32_bf16 v229, v238, v238, v229
  v_dot2_f32_bf16 v228, v239, v8, v228
  v_dot2_f32_bf16 v229, v239, v239, v229
  s_nop 2
  v_permlane32_swap_b32 v228, v229
  v_add_f32 v228, v228, v229
  buffer_store_dword v228, v46, s[36:39], s50 offen sc1
  s_or_b32 s51, s2, s46
  s_cmp_eq_u32 s51, 0
  s_cbranch_scc0 L_ar14
  s_mov_b64 exec, 1
  buffer_store_dword v12, off, s[36:39], 0 sc1
  s_mov_b64 exec, -1
L_ar14:
  ds_read_b64_tr_b16 a[40:41], v34 offset:0
  s_add_u32 s81, s81, 88064
  s_add_u32 m0, s69, 12288
  s_nop 0
  buffer_load_dwordx4 v27, s[16:19], s81 offen offset:0 lds
  ds_read_b64_tr_b16 a[42:43], v34 offset:3072
  ds_read_b64_tr_b16 a[168:169], v35 offset:0
  ds_read_b64_tr_b16 a[170:171], v35 offset:3072
  ds_read_b64_tr_b16 a[44:45], v34 offset:6144
  ds_read_b64_tr_b16 a[46:47], v34 offset:9216
  ds_read_b64_tr_b16 a[172:173], v35 offset:6144
  buffer_load_dwordx4 v28, s[16:19], s81 offen offset:1024 lds
  ds_read_b64_tr_b16 a[174:175], v35 offset:9216
  s_waitcnt lgkmcnt(6)
  v_mfma_f32_16x16x32_bf16 v[48:51], v[56:59], a[40:43], v[48:51]
  ds_read_b64_tr_b16 a[48:49], v34 offset:12288
  ds_read_b64_tr_b16 a[50:51], v34 offset:15360
  s_waitcnt lgkmcnt(6)
  v_mfma_f32_16x16x32_bf16 v[52:55], v[56:59], a[168:171], v[52:55]
  ds_read_b64_tr_b16 a[176:177], v35 offset:12288
  buffer_load_dwordx4 v29, s[16:19], s81 offen offset:2048 lds
  ds_read_b64_tr_b16 a[178:179], v35 offset:15360
  s_waitcnt lgkmcnt(6)
  v_mfma_f32_16x16x32_bf16 v[48:51], v[56:59], a[44:47], v[48:51]
  ds_read_b64_tr_b16 a[52:53], v34 offset:18432
  ds_read_b64_tr_b16 a[54:55], v34 offset:21504
  s_waitcnt lgkmcnt(6)
  v_mfma_f32_16x16x32_bf16 v[52:55], v[56:59], a[172:175], v[52:55]
  ds_read_b64_tr_b16 a[180:181], v35 offset:18432
  s_bfe_u32 s81, s28, 0x40018
  s_mul_i32 s81, s81, 176128
  s_add_u32 m0, s69, 24576
  s_nop 0
  buffer_load_dwordx4 v27, s[16:19], s81 offen offset:0 lds
  ds_read_b64_tr_b16 a[182:183], v35 offset:21504
  s_waitcnt lgkmcnt(6)
  v_mfma_f32_16x16x32_bf16 v[48:51], v[56:59], a[48:51], v[48:51]
  ds_read_b64_tr_b16 a[56:57], v34 offset:24576
  ds_read_b64_tr_b16 a[58:59], v34 offset:27648
  s_waitcnt lgkmcnt(6)
  v_mfma_f32_16x16x32_bf16 v[52:55], v[56:59], a[176:179], v[52:55]
  ds_read_b64_tr_b16 a[184:185], v35 offset:24576
  buffer_load_dwordx4 v28, s[16:19], s81 offen offset:1024 lds
  ds_read_b64_tr_b16 a[186:187], v35 offset:27648
  s_waitcnt lgkmcnt(6)
  v_mfma_f32_16x16x32_bf16 v[48:51], v[56:59], a[52:55], v[48:51]
  ds_read_b64_tr_b16 a[60:61], v34 offset:30720
  ds_read_b64_tr_b16 a[62:63], v34 offset:33792
  s_waitcnt lgkmcnt(6)
  v_mfma_f32_16x16x32_bf16 v[52:55], v[56:59], a[180:183], v[52:55]
  ds_read_b64_tr_b16 a[188:189], v35 offset:30720
  buffer_load_dwordx4 v29, s[16:19], s81 offen offset:2048 lds
  ds_read_b64_tr_b16 a[190:191], v35 offset:33792
  s_waitcnt lgkmcnt(6)
  v_mfma_f32_16x16x32_bf16 v[48:51], v[56:59], a[56:59], v[48:51]
  s_waitcnt lgkmcnt(4)
  v_mfma_f32_16x16x32_bf16 v[52:55], v[56:59], a[184:187], v[52:55]
  s_waitcnt lgkmcnt(2)
  v_mfma_f32_16x16x32_bf16 v[48:51], v[56:59], a[60:63], v[48:51]
  s_waitcnt lgkmcnt(0)
  v_mfma_f32_16x16x32_bf16 v[52:55], v[56:59], a[188:191], v[52:55]
  s_waitcnt vmcnt(6)
  s_barrier
  s_add_u32 s3, s41, 1024
  s_mov_b64 exec, 15
  buffer_store_dword v244, v13, s[36:39], s3 offen
  s_mov_b64 exec, -1
  ds_read_b64_tr_b16 a[64:65], v34 offset:36864
  s_add_u32 s81, s81, 88064
  s_add_u32 m0, s69, 131072
  s_nop 0
  buffer_load_dwordx4 v27, s[16:19], s81 offen offset:0 lds
  ds_read_b64_tr_b16 a[66:67], v34 offset:39936
  ds_read_b64_tr_b16 a[192:193], v35 offset:36864
  ds_read_b64_tr_b16 a[194:195], v35 offset:39936
  ds_read_b64_tr_b16 a[68:69], v34 offset:43008
  ds_read_b64_tr_b16 a[70:71], v34 offset:46080
  ds_read_b64_tr_b16 a[196:197], v35 offset:43008
  ds_read_b64_tr_b16 a[198:199], v35 offset:46080
  s_waitcnt lgkmcnt(6)
  v_mfma_f32_16x16x32_bf16 v[48:51], v[56:59], a[64:67], v[48:51]
  buffer_load_dwordx4 v28, s[16:19], s81 offen offset:1024 lds
  ds_read_b64_tr_b16 a[72:73], v34 offset:49152
  ds_read_b64_tr_b16 a[74:75], v34 offset:52224
  s_waitcnt lgkmcnt(6)
  v_mfma_f32_16x16x32_bf16 v[52:55], v[56:59], a[192:195], v[52:55]
  ds_read_b64_tr_b16 a[200:201], v35 offset:49152
  ds_read_b64_tr_b16 a[202:203], v35 offset:52224
  s_waitcnt lgkmcnt(6)
  v_mfma_f32_16x16x32_bf16 v[48:51], v[56:59], a[68:71], v[48:51]
  ds_read_b64_tr_b16 a[76:77], v34 offset:55296
  ds_read_b64_tr_b16 a[78:79], v34 offset:58368
  buffer_load_dwordx4 v29, s[16:19], s81 offen offset:2048 lds
  s_waitcnt lgkmcnt(6)
  v_mfma_f32_16x16x32_bf16 v[52:55], v[56:59], a[196:199], v[52:55]
  ds_read_b64_tr_b16 a[204:205], v35 offset:55296
  ds_read_b64_tr_b16 a[206:207], v35 offset:58368
  s_waitcnt lgkmcnt(6)
  v_mfma_f32_16x16x32_bf16 v[48:51], v[56:59], a[72:75], v[48:51]
  ds_read_b64_tr_b16 a[80:81], v32 offset:0
  ds_read_b64_tr_b16 a[82:83], v32 offset:3072
  s_waitcnt lgkmcnt(6)
  v_mfma_f32_16x16x32_bf16 v[52:55], v[56:59], a[200:203], v[52:55]
  ds_read_b64_tr_b16 a[208:209], v33 offset:0
  ds_read_b64_tr_b16 a[210:211], v33 offset:3072
  s_bfe_u32 s81, s28, 0x4001c
  s_mul_i32 s81, s81, 176128
  s_add_u32 m0, s69, 143360
  s_nop 0
  buffer_load_dwordx4 v27, s[16:19], s81 offen offset:0 lds
  s_waitcnt lgkmcnt(6)
  v_mfma_f32_16x16x32_bf16 v[48:51], v[56:59], a[76:79], v[48:51]
  ds_read_b64_tr_b16 a[84:85], v32 offset:6144
  ds_read_b64_tr_b16 a[86:87], v32 offset:9216
  s_waitcnt lgkmcnt(6)
  v_mfma_f32_16x16x32_bf16 v[52:55], v[56:59], a[204:207], v[52:55]
  ds_read_b64_tr_b16 a[212:213], v33 offset:6144
  ds_read_b64_tr_b16 a[214:215], v33 offset:9216
  s_waitcnt lgkmcnt(6)
  v_mfma_f32_16x16x32_bf16 v[48:51], v[56:59], a[80:83], v[48:51]
  s_waitcnt lgkmcnt(4)
  v_mfma_f32_16x16x32_bf16 v[52:55], v[56:59], a[208:211], v[52:55]
  buffer_load_dwordx4 v28, s[16:19], s81 offen offset:1024 lds
  s_waitcnt lgkmcnt(2)
  v_mfma_f32_16x16x32_bf16 v[48:51], v[56:59], a[84:87], v[48:51]
  s_waitcnt lgkmcnt(0)
  v_mfma_f32_16x16x32_bf16 v[52:55], v[56:59], a[212:215], v[52:55]
  v_add_u32 v38, 65536, v2
  s_lshl_b32 s51, s47, 15
  v_add_u32 v39, s51, v38
  s_lshl_b32 s51, s46, 9
  s_add_u32 s51, s51, 160768
  v_lshl_add_u32 v60, v5, 2, v3
  v_lshl_add_u32 v40, v60, 5, s51
  buffer_load_dwordx4 v29, s[16:19], s81 offen offset:2048 lds
  v_and_b32 v60, 31, v1
  v_lshlrev_b32 v60, 5, v60
  v_add_u32 v41, 160768, v60
  s_lshl_b32 s51, s47, 10
  v_add_u32 v46, s51, v41
  s_mul_i32 s51, s46, 2080
  v_xor_b32 v42, s51, v47
  v_xor_b32 v43, 64, v42
  s_add_u32 s81, s81, 88064
  s_add_u32 m0, s69, 49152
  s_nop 0
  buffer_load_dwordx4 v27, s[16:19], s81 offen offset:0 lds
  v_add_u32 v44, 131072, v42
  v_add_u32 v45, 131072, v43
  v_mov_b64 v[64:65], 0
  v_mov_b64 v[66:67], 0
  v_mov_b64 v[68:69], 0
  v_mov_b64 v[70:71], 0
  s_add_u32 s49, s54, s40
  s_add_u32 s49, s49, 81920
  v_add_u32 v63, s49, v2
  buffer_load_dwordx4 v28, s[16:19], s81 offen offset:1024 lds
  s_lshl_b32 s49, s44, 12
  s_lshl_b32 s50, s48, 11
  v_add_u32 v61, s50, v39
  s_add_u32 s51, s68, s40
  s_add_u32 s51, s51, 344064
  s_add_u32 s57, s70, 65536
  v_add_u32 v24, s57, v30
  v_add_u32 v25, s57, v31
  buffer_load_dwordx4 v29, s[16:19], s81 offen offset:2048 lds
  s_mov_b32 s52, s44
  s_lshl_b32 s52, s52, 2
  s_mov_b32 s64, 0x06543210
  s_mov_b32 s65, 0x00654321
  s_lshr_b64 s[64:65], s[64:65], s52
  s_mov_b32 s66, 0x76543210
  s_mov_b32 s67, 0x76543210
  s_lshr_b64 s[66:67], s[66:67], s52
  s_waitcnt vmcnt(10)
  s_barrier
  s_add_u32 s71, s40, 1024
  s_mov_b32 s55, 0
L_sp15:
  s_load_dwordx8 s[84:91], s[36:37], s71
  s_add_u32 s71, s71, 64
  s_add_u32 s55, s55, 1
  s_cmp_gt_u32 s55, 16
  s_cbranch_scc1 L_pc18
  s_waitcnt lgkmcnt(0)
  s_xor_b64 s[84:85], s[84:85], s[0:1]
  s_xor_b64 s[86:87], s[86:87], s[0:1]
  s_xor_b64 s[88:89], s[88:89], s[0:1]
  s_xor_b64 s[90:91], s[90:91], s[0:1]
  s_or_b64 s[84:85], s[84:85], s[88:89]
  s_or_b64 s[86:87], s[86:87], s[90:91]
  s_or_b64 s[84:85], s[84:85], s[86:87]
  s_cbranch_scc1 L_sp15
L_pollo17:
  s_bfe_u32 s49, s28, 0x40004
  s_lshl_b32 s49, s49, 12
  s_add_u32 m0, s54, 69632
  s_nop 0
  buffer_load_dwordx4 v63, s[36:39], s49 offen sc1 lds
  s_bfe_u32 s49, s28, 0x40008
  s_lshl_b32 s49, s49, 12
  s_add_u32 m0, s54, 73728
  s_nop 0
  buffer_load_dwordx4 v63, s[36:39], s49 offen sc1 lds
  s_bfe_u32 s49, s28, 0x4000c
  s_lshl_b32 s49, s49, 12
  s_add_u32 m0, s54, 77824
  s_nop 0
  buffer_load_dwordx4 v63, s[36:39], s49 offen sc1 lds
  s_bfe_u32 s49, s28, 0x40010
  s_lshl_b32 s49, s49, 12
  s_add_u32 m0, s54, 81920
  s_nop 0
  buffer_load_dwordx4 v63, s[36:39], s49 offen sc1 lds
  ds_write_b128 v61, v[232:235] offset:0
  ds_write_b128 v61, v[236:239] offset:1024
  ds_read_b64_tr_b16 a[88:89], v32 offset:12288
  ds_read_b64_tr_b16 a[90:91], v32 offset:15360
  ds_read_b64_tr_b16 a[216:217], v33 offset:12288
  s_bfe_u32 s49, s28, 0x40014
  s_lshl_b32 s49, s49, 12
  s_add_u32 m0, s54, 86016
  s_nop 0
  buffer_load_dwordx4 v63, s[36:39], s49 offen sc1 lds
  ds_read_b64_tr_b16 a[218:219], v33 offset:15360
  ds_read_b64_tr_b16 a[92:93], v32 offset:18432
  ds_read_b64_tr_b16 a[94:95], v32 offset:21504
  ds_read_b64_tr_b16 a[220:221], v33 offset:18432
  s_bfe_u32 s49, s28, 0x40018
  s_lshl_b32 s49, s49, 12
  s_add_u32 m0, s54, 90112
  s_nop 0
  buffer_load_dwordx4 v63, s[36:39], s49 offen sc1 lds
  ds_read_b64_tr_b16 a[222:223], v33 offset:21504
  s_waitcnt lgkmcnt(6)
  v_mfma_f32_16x16x32_bf16 v[48:51], v[56:59], a[88:91], v[48:51]
  ds_read_b64_tr_b16 a[96:97], v32 offset:24576
  ds_read_b64_tr_b16 a[98:99], v32 offset:27648
  s_bfe_u32 s49, s28, 0x4001c
  s_lshl_b32 s49, s49, 12
  s_add_u32 m0, s54, 94208
  s_nop 0
  buffer_load_dwordx4 v63, s[36:39], s49 offen sc1 lds
  s_waitcnt lgkmcnt(6)
  v_mfma_f32_16x16x32_bf16 v[52:55], v[56:59], a[216:219], v[52:55]
  ds_read_b64_tr_b16 a[224:225], v33 offset:24576
  ds_read_b64_tr_b16 a[226:227], v33 offset:27648
  s_waitcnt lgkmcnt(6)
  v_mfma_f32_16x16x32_bf16 v[48:51], v[56:59], a[92:95], v[48:51]
  ds_read_b64_tr_b16 a[100:101], v32 offset:30720
  buffer_load_dwordx4 v[72:75], v2, s[36:39], s51 offen offset:0 sc1
  ds_read_b64_tr_b16 a[102:103], v32 offset:33792
  s_waitcnt lgkmcnt(6)
  v_mfma_f32_16x16x32_bf16 v[52:55], v[56:59], a[220:223], v[52:55]
  ds_read_b64_tr_b16 a[228:229], v33 offset:30720
  ds_read_b64_tr_b16 a[230:231], v33 offset:33792
  buffer_load_dwordx4 v[76:79], v2, s[36:39], s51 offen offset:1024 sc1
  s_waitcnt lgkmcnt(6)
  v_mfma_f32_16x16x32_bf16 v[48:51], v[56:59], a[96:99], v[48:51]
  s_waitcnt lgkmcnt(4)
  v_mfma_f32_16x16x32_bf16 v[52:55], v[56:59], a[224:227], v[52:55]
  s_waitcnt lgkmcnt(2)
  v_mfma_f32_16x16x32_bf16 v[48:51], v[56:59], a[100:103], v[48:51]
  s_waitcnt lgkmcnt(0)
  v_mfma_f32_16x16x32_bf16 v[52:55], v[56:59], a[228:231], v[52:55]
  s_add_u32 s56, s70, s40
  s_mov_b32 s51, s44
  s_add_u32 s52, s51, 1
  s_and_b32 s52, s52, 8
  s_lshl_b32 s52, s52, 27
  s_lshl_b32 s51, s51, 11
  s_add_u32 s51, s56, s51
  s_add_u32 s52, s52, s51
  s_add_u32 s72, s52, 147456
  s_add_u32 s58, s52, 278528
  s_mul_i32 s52, s47, 15360
  s_sub_u32 s73, s51, s52
  s_add_u32 s73, s73, 212992
  s_add_u32 s74, s73, 16384
  s_lshl_b32 s52, s48, 10
  s_add_u32 s61, s52, s40
  s_lshl_b32 s60, s47, 5
  s_add_u32 s52, s52, s60
  s_add_u32 s60, s52, s40
  v_lshl_add_u32 v13, v7, 6, s52
  v_add_u32 v34, 65536, v42
  v_add_u32 v35, 65536, v43
  v_add_u32 v62, s54, v38
  s_waitcnt vmcnt(6)
  s_barrier
  ds_read_b128 v[112:115], v38 offset:0
  ds_read_b128 v[116:119], v38 offset:1024
  ds_read_b128 v[120:123], v38 offset:2048
  s_waitcnt lgkmcnt(2)
  v_mfma_f32_32x32x16_bf16 v[80:95], a[0:3], v[112:115], 0
  s_or_b32 s28, s28, 0x88888888
  s_bfe_u32 s49, s28, 0x40004
  s_lshl_b32 s49, s49, 12
  ds_read_b128 v[124:127], v38 offset:3072
  ds_read_b128 v[128:131], v38 offset:4096
L_pad4:
  s_cbranch_execz L_padback2
  ds_read_b64_tr_b16 a[104:105], v36 offset:0
  ds_read_b64_tr_b16 a[106:107], v36 offset:3072
  ds_read_b64_tr_b16 a[232:233], v37 offset:0
  s_waitcnt lgkmcnt(6)
  v_mfma_f32_32x32x16_bf16 v[80:95], a[4:7], v[116:119], v[80:95]
  s_add_u32 m0, s54, 102400
  s_nop 0
  buffer_load_dwordx4 v63, s[36:39], s49 offen sc1 lds
  ds_read_b128 v[132:135], v38 offset:5120
  ds_read_b128 v[136:139], v38 offset:6144
  ds_read_b64_tr_b16 a[234:235], v37 offset:3072
  ds_read_b64_tr_b16 a[108:109], v36 offset:6144
  ds_read_b64_tr_b16 a[110:111], v36 offset:9216
  s_waitcnt lgkmcnt(10)
  v_mfma_f32_32x32x16_bf16 v[80:95], a[8:11], v[120:123], v[80:95]
  s_bfe_u32 s49, s28, 0x40008
  s_lshl_b32 s49, s49, 12
  ds_read_b128 v[140:143], v38 offset:7168
  ds_read_b128 v[112:115], v38 offset:8192
  ds_read_b64_tr_b16 a[236:237], v37 offset:6144
  ds_read_b64_tr_b16 a[238:239], v37 offset:9216
  ds_read_b64_tr_b16 a[112:113], v36 offset:12288
  s_waitcnt lgkmcnt(14)
  v_mfma_f32_32x32x16_bf16 v[80:95], a[12:15], v[124:127], v[80:95]
  s_add_u32 m0, s54, 106496
  s_nop 0
  buffer_load_dwordx4 v63, s[36:39], s49 offen sc1 lds
  ds_read_b128 v[116:119], v38 offset:9216
  ds_read_b128 v[120:123], v38 offset:10240
  ds_read_b64_tr_b16 a[114:115], v36 offset:15360
  ds_read_b64_tr_b16 a[240:241], v37 offset:12288
  ds_read_b64_tr_b16 a[242:243], v37 offset:15360
  s_waitcnt lgkmcnt(14)
  v_mfma_f32_32x32x16_bf16 v[80:95], a[16:19], v[128:131], v[80:95]
  s_waitcnt lgkmcnt(8)
  ds_read_b128 v[124:127], v38 offset:11264
  ds_read_b64_tr_b16 a[116:117], v36 offset:18432
  ds_read_b64_tr_b16 a[118:119], v36 offset:21504
  ds_read_b64_tr_b16 a[244:245], v37 offset:18432
  v_mfma_f32_32x32x16_bf16 v[80:95], a[20:23], v[132:135], v[80:95]
  s_bfe_u32 s49, s28, 0x4000c
  s_lshl_b32 s49, s49, 12
  s_add_u32 m0, s54, 110592
  ds_read_b128 v[128:131], v38 offset:12288
  ds_read_b64_tr_b16 a[246:247], v37 offset:21504
  ds_read_b64_tr_b16 a[120:121], v32 offset:49152
  ds_read_b64_tr_b16 a[122:123], v32 offset:52224
  v_mfma_f32_32x32x16_bf16 v[80:95], a[24:27], v[136:139], v[80:95]
  buffer_load_dwordx4 v63, s[36:39], s49 offen sc1 lds
  s_bfe_u32 s49, s28, 0x40010
  ds_read_b128 v[132:135], v38 offset:13312
  ds_read_b64_tr_b16 a[248:249], v33 offset:49152
  ds_read_b64_tr_b16 a[250:251], v33 offset:52224
  ds_read_b64_tr_b16 a[124:125], v32 offset:55296
  v_mfma_f32_32x32x16_bf16 v[80:95], a[28:31], v[140:143], v[80:95]
  s_lshl_b32 s49, s49, 12
  s_add_u32 m0, s54, 114688
  ds_read_b128 v[136:139], v38 offset:14336
  ds_read_b64_tr_b16 a[126:127], v32 offset:58368
  ds_read_b64_tr_b16 a[252:253], v33 offset:55296
  ds_read_b64_tr_b16 a[254:255], v33 offset:58368
  v_mfma_f32_32x32x16_bf16 v[80:95], a[32:35], v[112:115], v[80:95]
  s_waitcnt lgkmcnt(11)
  ds_read_b128 v[140:143], v38 offset:15360
  v_mfma_f32_32x32x16_bf16 v[80:95], a[36:39], v[116:119], v[80:95]
  s_waitcnt vmcnt(5) lgkmcnt(1)
  s_barrier
  ds_read_b128 v[112:115], v38 offset:16384
  v_mfma_f32_32x32x16_bf16 v[80:95], a[40:43], v[120:123], v[80:95]
  buffer_load_dwordx4 v63, s[36:39], s49 offen sc1 lds
  s_bfe_u32 s49, s28, 0x40014
  ds_read_b128 v[116:119], v38 offset:17408
  s_waitcnt vmcnt(4)
  v_add_f32 v72, v72, v76
  v_add_f32 v73, v73, v77
  v_add_f32 v74, v74, v78
  v_mfma_f32_16x16x32_bf16 v[48:51], v[56:59], a[104:107], v[48:51]
  v_mfma_f32_16x16x32_bf16 v[52:55], v[56:59], a[232:235], v[52:55]
  v_mfma_f32_16x16x32_bf16 v[48:51], v[56:59], a[108:111], v[48:51]
  v_mfma_f32_16x16x32_bf16 v[52:55], v[56:59], a[236:239], v[52:55]
  v_mfma_f32_16x16x32_bf16 v[48:51], v[56:59], a[112:115], v[48:51]
  v_mfma_f32_16x16x32_bf16 v[52:55], v[56:59], a[240:243], v[52:55]
  v_mfma_f32_16x16x32_bf16 v[48:51], v[56:59], a[116:119], v[48:51]
  v_mfma_f32_16x16x32_bf16 v[52:55], v[56:59], a[244:247], v[52:55]
  v_mfma_f32_16x16x32_bf16 v[48:51], v[56:59], a[120:123], v[48:51]
  v_mfma_f32_16x16x32_bf16 v[52:55], v[56:59], a[248:251], v[52:55]
  v_mfma_f32_16x16x32_bf16 v[48:51], v[56:59], a[124:127], v[48:51]
  v_mfma_f32_16x16x32_bf16 v[52:55], v[56:59], a[252:255], v[52:55]
  v_mfma_f32_32x32x16_bf16 v[80:95], a[44:47], v[124:127], v[80:95]
  s_lshl_b32 s49, s49, 12
  s_add_u32 m0, s54, 118784
  s_nop 0
  buffer_load_dwordx4 v63, s[36:39], s49 offen sc1 lds
  ds_read_b128 v[120:123], v38 offset:18432
  v_add_f32 v75, v75, v79
  v_permlane16_swap_b32 v72, v73
  v_mfma_f32_32x32x16_bf16 v[80:95], a[48:51], v[128:131], v[80:95]
  s_waitcnt lgkmcnt(2)
  ds_read_b128 v[124:127], v38 offset:19456
  v_permlane16_swap_b32 v74, v75
  v_add_f32 v72, v72, v73
  v_mfma_f32_32x32x16_bf16 v[80:95], a[52:55], v[132:135], v[80:95]
  s_bfe_u32 s49, s28, 0x40018
  s_lshl_b32 s49, s49, 12
  ds_read_b128 v[128:131], v38 offset:20480
  v_add_f32 v74, v74, v75
  s_nop 1
  v_permlane32_swap_b32 v72, v74
  v_add_f32 v73, v72, v74
  v_mfma_f32_32x32x16_bf16 v[80:95], a[56:59], v[136:139], v[80:95]
  s_add_u32 m0, s54, 122880
  s_nop 0
  buffer_load_dwordx4 v63, s[36:39], s49 offen sc1 lds
  ds_read_b128 v[132:135], v38 offset:21504
  v_add_f32_dpp v72, v73, v73 row_ror:8 row_mask:0xf bank_mask:0xf
  s_nop 1
  v_mov_b32_dpp v73, v72 row_ror:4 row_mask:0xf bank_mask:0xf
  v_mfma_f32_32x32x16_bf16 v[80:95], a[60:63], v[140:143], v[80:95]
  s_bfe_u32 s49, s28, 0x4001c
  s_lshl_b32 s49, s49, 12
  ds_read_b128 v[136:139], v38 offset:22528
  v_mul_f32 v72, 0xbb000000, v72
  v_mul_f32 v73, 0x3b000000, v73
  v_mfma_f32_32x32x16_bf16 v[80:95], a[64:67], v[112:115], v[80:95]
  s_waitcnt lgkmcnt(2)
  ds_read_b128 v[140:143], v38 offset:23552
  v_fma_f32 v73, -v72, v72, v73
  v_max_f32 v73, 0, v73
  v_mfma_f32_32x32x16_bf16 v[80:95], a[68:71], v[116:119], v[80:95]
  s_add_u32 m0, s54, 126976
  s_nop 0
  buffer_load_dwordx4 v63, s[36:39], s49 offen sc1 lds
  s_bfe_u32 s81, s64, 0x40000
  ds_read_b128 v[112:115], v38 offset:24576
  v_add_f32 v73, 0x3727c5ac, v73
  v_rsq_f32 v74, v73
  v_cvt_pk_bf16_f32 v156, v72, v72
  v_mfma_f32_32x32x16_bf16 v[80:95], a[72:75], v[120:123], v[80:95]
  s_mul_i32 s81, s81, 196608
  s_add_u32 m0, s68, 0
  ds_read_b128 v[116:119], v38 offset:25600
  v_mul_f32 v162, v73, v74
  v_and_b32 v75, s80, v156
  v_mfma_f32_32x32x16_bf16 v[80:95], a[76:79], v[124:127], v[80:95]
  buffer_load_dwordx4 v24, s[24:27], s81 offen lds
  buffer_load_dwordx4 v25, s[24:27], s81 offen offset:1024 lds
  ds_read_b128 v[120:123], v38 offset:26624
  v_sub_f32 v75, v72, v75
  v_cvt_pk_bf16_f32 v157, v75, v162
  v_mfma_f32_32x32x16_bf16 v[80:95], a[80:83], v[128:131], v[80:95]
  s_waitcnt lgkmcnt(2)
  ds_read_b128 v[124:127], v38 offset:27648
  v_mul_f32 v161, 0xc0135761, v74
  v_mul_f32 v74, v74, v74
  v_and_b32 v75, s80, v157
  v_mfma_f32_32x32x16_bf16 v[80:95], a[84:87], v[132:135], v[80:95]
  s_add_u32 s81, s81, 16384
  s_add_u32 m0, s68, 40960
  ds_read_b128 v[128:131], v38 offset:28672
  v_sub_f32 v75, v162, v75
  v_mul_f32 v74, 0x3d372713, v74
  v_mfma_f32_32x32x16_bf16 v[80:95], a[88:91], v[136:139], v[80:95]
  buffer_load_dwordx4 v24, s[24:27], s81 offen lds
  buffer_load_dwordx4 v25, s[24:27], s81 offen offset:1024 lds
  s_bfe_u32 s81, s64, 0x40004
  ds_read_b128 v[132:135], v38 offset:29696
  v_cvt_pk_bf16_f32 v158, v75, 0
  v_mov_b32 v159, 0
  v_mfma_f32_32x32x16_bf16 v[80:95], a[92:95], v[140:143], v[80:95]
  s_mul_i32 s81, s81, 196608
  s_add_u32 m0, s68, 8192
  ds_read_b128 v[136:139], v38 offset:30720
  v_mul_f32 v160, v74, v161
  s_mov_b32 exec_lo, 0x000f000f
  s_mov_b32 exec_hi, 0x000f000f
  ds_write_b128 v40, v[156:159]
  ds_write_b96 v40, v[160:162] offset:16
  s_mov_b64 exec, -1
  v_mfma_f32_32x32x16_bf16 v[80:95], a[96:99], v[112:115], v[80:95]
  s_waitcnt lgkmcnt(4)
  ds_read_b128 v[140:143], v38 offset:31744
  v_mfma_f32_32x32x16_bf16 v[80:95], a[100:103], v[116:119], v[80:95]
  s_waitcnt vmcnt(8) lgkmcnt(1)
  s_barrier
  ds_read_b128 v[112:115], v39 offset:0
  v_mfma_f32_32x32x16_bf16 v[80:95], a[104:107], v[120:123], v[80:95]
  buffer_load_dwordx4 v24, s[24:27], s81 offen lds
  buffer_load_dwordx4 v25, s[24:27], s81 offen offset:1024 lds
  ds_read_b128 v[116:119], v39 offset:1024
  v_mfma_f32_32x32x16_bf16 v[80:95], a[108:111], v[124:127], v[80:95]
  s_add_u32 s81, s81, 16384
  s_add_u32 m0, s68, 16384
  ds_read_b128 v[120:123], v39 offset:2048
  ds_read_b128 v[144:147], v41 offset:0
  ds_read_b96 v[148:150], v41 offset:16
  v_mfma_f32_32x32x16_bf16 v[80:95], a[112:115], v[128:131], v[80:95]
  s_waitcnt lgkmcnt(4)
  ds_read_b128 v[124:127], v39 offset:3072
  v_mfma_f32_32x32x16_bf16 v[80:95], a[116:119], v[132:135], v[80:95]
  buffer_load_dwordx4 v24, s[24:27], s81 offen lds
  buffer_load_dwordx4 v25, s[24:27], s81 offen offset:1024 lds
  ds_read_b128 v[128:131], v39 offset:4096
  v_mfma_f32_32x32x16_bf16 v[80:95], a[120:123], v[136:139], v[80:95]
  s_mov_b32 exec_hi, 0
  v_cvt_pk_bf16_f32 v60, v48, v48
  v_and_b32 v60, s80, v60
  v_sub_f32 v60, v48, v60
  v_cvt_pk_bf16_f32 v64, v48, v60
  v_perm_b32 v65, v248, v64, s77
  v_mov_b32 v66, v248
  v_cvt_pk_bf16_f32 v60, v52, v52
  v_and_b32 v60, s80, v60
  v_sub_f32 v60, v52, v60
  v_cvt_pk_bf16_f32 v68, v52, v60
  v_perm_b32 v69, v249, v68, s77
  v_mov_b32 v70, v249
  s_mov_b32 exec_hi, -1
  ds_read_b128 v[132:135], v39 offset:5120
  v_mfma_f32_32x32x16_bf16 v[80:95], a[124:127], v[140:143], v[80:95]
  ds_read_b128 v[136:139], v39 offset:6144
  s_waitcnt lgkmcnt(5)
  v_mfma_f32_32x32x16_bf16 v[80:95], v[64:67], v[144:147], v[80:95]
  v_mfma_f32_32x32x16_bf16 v[96:111], a[128:131], v[112:115], 0
  s_waitcnt lgkmcnt(2)
  ds_read_b128 v[140:143], v39 offset:7168
  v_mfma_f32_32x32x16_bf16 v[96:111], a[132:135], v[116:119], v[96:111]
  s_bfe_u32 s81, s64, 0x40008
  s_mul_i32 s81, s81, 196608
  ds_read_b128 v[112:115], v39 offset:8192
  ds_read_b128 v[16:19], v62
  s_nop 3
  v_mul_f32 v156, v80, v80
  v_mul_f32 v157, v81, v81
  v_fma_f32 v156, v156, v148, v149
  v_fma_f32 v157, v157, v148, v149
  v_mfma_f32_32x32x16_bf16 v[96:111], a[136:139], v[120:123], v[96:111]
  s_add_u32 m0, s68, 24576
  ds_read_b128 v[116:119], v39 offset:9216
  v_mul_f32 v156, v156, v80
  v_mul_f32 v157, v157, v81
  v_exp_f32 v156, v156
  v_exp_f32 v157, v157
  v_mfma_f32_32x32x16_bf16 v[96:111], a[140:143], v[124:127], v[96:111]
  buffer_load_dwordx4 v24, s[24:27], s81 offen lds
  buffer_load_dwordx4 v25, s[24:27], s81 offen offset:1024 lds
  ds_read_b128 v[120:123], v39 offset:10240
  v_fma_f32 v156, v156, v150, v150
  v_mfma_f32_32x32x16_bf16 v[96:111], a[144:147], v[128:131], v[96:111]
  s_waitcnt lgkmcnt(3)
  ds_read_b128 v[124:127], v39 offset:11264
  v_fma_f32 v157, v157, v150, v150
  v_rcp_f32 v156, v156
  v_rcp_f32 v157, v157
  v_mul_f32 v156, v156, v80
  v_mfma_f32_32x32x16_bf16 v[96:111], a[148:151], v[132:135], v[96:111]
  s_add_u32 s81, s81, 16384
  ds_read_b128 v[128:131], v39 offset:12288
  v_mul_f32 v157, v157, v81
  v_cvt_pk_bf16_f32 v164, v156, v157
  v_mul_f32 v158, v82, v82
  v_mul_f32 v159, v83, v83
  v_fma_f32 v158, v158, v148, v149
  v_fma_f32 v159, v159, v148, v149
  v_mfma_f32_32x32x16_bf16 v[96:111], a[152:155], v[136:139], v[96:111]
  s_add_u32 m0, s68, 32768
  ds_read_b128 v[132:135], v39 offset:13312
  v_mul_f32 v158, v158, v82
  v_mul_f32 v159, v159, v83
  v_exp_f32 v158, v158
  v_exp_f32 v159, v159
  v_mfma_f32_32x32x16_bf16 v[96:111], a[156:159], v[140:143], v[96:111]
  buffer_load_dwordx4 v24, s[24:27], s81 offen lds
  buffer_load_dwordx4 v25, s[24:27], s81 offen offset:1024 lds
  ds_read_b128 v[136:139], v39 offset:14336
  v_fma_f32 v158, v158, v150, v150
  v_mfma_f32_32x32x16_bf16 v[96:111], a[160:163], v[112:115], v[96:111]
  s_waitcnt lgkmcnt(2)
  ds_read_b128 v[140:143], v39 offset:15360
  v_fma_f32 v159, v159, v150, v150
  v_rcp_f32 v158, v158
  v_rcp_f32 v159, v159
  v_mul_f32 v158, v158, v82
  v_mfma_f32_32x32x16_bf16 v[96:111], a[164:167], v[116:119], v[96:111]
  s_waitcnt vmcnt(12)
  s_barrier
  ds_read_b128 v[112:115], v39 offset:16384
  v_mul_f32 v159, v159, v83
  v_cvt_pk_bf16_f32 v165, v158, v159
  v_mul_f32 v160, v84, v84
  v_mul_f32 v161, v85, v85
  v_fma_f32 v160, v160, v148, v149
  v_mfma_f32_32x32x16_bf16 v[96:111], a[168:171], v[120:123], v[96:111]
  s_bfe_u32 s81, s64, 0x4000c
  ds_read_b128 v[116:119], v39 offset:17408
  v_fma_f32 v161, v161, v148, v149
  v_mul_f32 v160, v160, v84
  v_mul_f32 v161, v161, v85
  v_exp_f32 v160, v160
  v_exp_f32 v161, v161
  v_mfma_f32_32x32x16_bf16 v[96:111], a[172:175], v[124:127], v[96:111]
  s_mul_i32 s81, s81, 196608
  s_add_u32 m0, s68, 49152
  ds_read_b128 v[120:123], v39 offset:18432
  v_fma_f32 v160, v160, v150, v150
  v_fma_f32 v161, v161, v150, v150
  v_rcp_f32 v160, v160
  v_rcp_f32 v161, v161
  v_mfma_f32_32x32x16_bf16 v[96:111], a[176:179], v[128:131], v[96:111]
  s_waitcnt lgkmcnt(2)
  ds_read_b128 v[124:127], v39 offset:19456
  v_mul_f32 v160, v160, v84
  v_mul_f32 v161, v161, v85
  v_cvt_pk_bf16_f32 v166, v160, v161
  v_mul_f32 v162, v86, v86
  v_mul_f32 v163, v87, v87
  v_fma_f32 v162, v162, v148, v149
  v_mfma_f32_32x32x16_bf16 v[96:111], a[180:183], v[132:135], v[96:111]
  buffer_load_dwordx4 v24, s[24:27], s81 offen lds
  ds_read_b128 v[128:131], v39 offset:20480
  v_fma_f32 v163, v163, v148, v149
  v_mul_f32 v162, v162, v86
  v_mul_f32 v163, v163, v87
  v_mfma_f32_32x32x16_bf16 v[96:111], a[184:187], v[136:139], v[96:111]
  buffer_load_dwordx4 v25, s[24:27], s81 offen offset:1024 lds
  ds_read_b128 v[132:135], v39 offset:21504
  v_exp_f32 v162, v162
  v_exp_f32 v163, v163
  v_mfma_f32_32x32x16_bf16 v[96:111], a[188:191], v[140:143], v[96:111]
  s_add_u32 s81, s81, 16384
  s_add_u32 m0, s68, 57344
  ds_read_b128 v[136:139], v39 offset:22528
  v_fma_f32 v162, v162, v150, v150
  v_fma_f32 v163, v163, v150, v150
  v_rcp_f32 v162, v162
  v_rcp_f32 v163, v163
  v_mfma_f32_32x32x16_bf16 v[96:111], a[192:195], v[112:115], v[96:111]
  s_waitcnt lgkmcnt(2)
  ds_read_b128 v[140:143], v39 offset:23552
  v_mul_f32 v162, v162, v86
  v_mul_f32 v163, v163, v87
  v_cvt_pk_bf16_f32 v167, v162, v163
  v_mul_f32 v156, v88, v88
  v_mul_f32 v157, v89, v89
  v_fma_f32 v156, v156, v148, v149
  v_mfma_f32_32x32x16_bf16 v[96:111], a[196:199], v[116:119], v[96:111]
  buffer_load_dwordx4 v24, s[24:27], s81 offen lds
  ds_read_b128 v[112:115], v39 offset:24576
  v_fma_f32 v157, v157, v148, v149
  v_mul_f32 v156, v156, v88
  v_mul_f32 v157, v157, v89
  v_exp_f32 v156, v156
  v_mfma_f32_32x32x16_bf16 v[96:111], a[200:203], v[120:123], v[96:111]
  buffer_load_dwordx4 v25, s[24:27], s81 offen offset:1024 lds
  s_bfe_u32 s81, s64, 0x40010
  ds_read_b128 v[116:119], v39 offset:25600
  v_exp_f32 v157, v157
  v_fma_f32 v156, v156, v150, v150
  v_mfma_f32_32x32x16_bf16 v[96:111], a[204:207], v[124:127], v[96:111]
  s_mul_i32 s81, s81, 196608
  ds_read_b128 v[120:123], v39 offset:26624
  v_fma_f32 v157, v157, v150, v150
  v_rcp_f32 v156, v156
  v_rcp_f32 v157, v157
  v_mul_f32 v156, v156, v88
  v_mfma_f32_32x32x16_bf16 v[96:111], a[208:211], v[128:131], v[96:111]
  s_waitcnt lgkmcnt(2)
  ds_read_b128 v[124:127], v39 offset:27648
  v_mul_f32 v157, v157, v89
  v_cvt_pk_bf16_f32 v168, v156, v157
  v_mul_f32 v158, v90, v90
  v_mul_f32 v159, v91, v91
  v_fma_f32 v158, v158, v148, v149
  v_fma_f32 v159, v159, v148, v149
  v_mfma_f32_32x32x16_bf16 v[96:111], a[212:215], v[132:135], v[96:111]
  s_add_u32 m0, s68, 131072
  ds_read_b128 v[128:131], v39 offset:28672
  v_mul_f32 v158, v158, v90
  v_mul_f32 v159, v159, v91
  v_exp_f32 v158, v158
  v_exp_f32 v159, v159
  v_mfma_f32_32x32x16_bf16 v[96:111], a[216:219], v[136:139], v[96:111]
  buffer_load_dwordx4 v24, s[24:27], s81 offen lds
  buffer_load_dwordx4 v25, s[24:27], s81 offen offset:1024 lds
  ds_read_b128 v[132:135], v39 offset:29696
  v_fma_f32 v158, v158, v150, v150
  v_mfma_f32_32x32x16_bf16 v[96:111], a[220:223], v[140:143], v[96:111]
  s_add_u32 s81, s81, 16384
  ds_read_b128 v[136:139], v39 offset:30720
  v_fma_f32 v159, v159, v150, v150
  v_rcp_f32 v158, v158
  v_rcp_f32 v159, v159
  v_mul_f32 v158, v158, v90
  v_mfma_f32_32x32x16_bf16 v[96:111], a[224:227], v[112:115], v[96:111]
  s_waitcnt lgkmcnt(2)
  ds_read_b128 v[140:143], v39 offset:31744
  v_mul_f32 v159, v159, v91
  v_cvt_pk_bf16_f32 v169, v158, v159
  v_mul_f32 v160, v92, v92
  v_mul_f32 v161, v93, v93
  v_fma_f32 v160, v160, v148, v149
  v_fma_f32 v161, v161, v148, v149
  v_mfma_f32_32x32x16_bf16 v[96:111], a[228:231], v[116:119], v[96:111]
  s_add_u32 m0, s68, 139264
  s_nop 0
  buffer_load_dwordx4 v24, s[24:27], s81 offen lds
  ds_read_b128 v[112:115], v38 offset:32768
  v_mul_f32 v160, v160, v92
  v_mul_f32 v161, v161, v93
  v_exp_f32 v160, v160
  v_mfma_f32_32x32x16_bf16 v[96:111], a[232:235], v[120:123], v[96:111]
  buffer_load_dwordx4 v25, s[24:27], s81 offen offset:1024 lds
  ds_read_b128 v[116:119], v38 offset:33792
  v_exp_f32 v161, v161
  v_fma_f32 v160, v160, v150, v150
  v_fma_f32 v161, v161, v150, v150
  v_mfma_f32_32x32x16_bf16 v[96:111], a[236:239], v[124:127], v[96:111]
  s_bfe_u32 s81, s64, 0x40014
  ds_read_b128 v[120:123], v38 offset:34816
  ds_read_b128 v[144:147], v46 offset:0
  ds_read_b96 v[152:154], v46 offset:16
  v_rcp_f32 v160, v160
  v_rcp_f32 v161, v161
  v_mfma_f32_32x32x16_bf16 v[96:111], a[240:243], v[128:131], v[96:111]
  s_waitcnt lgkmcnt(4)
  ds_read_b128 v[124:127], v38 offset:35840
  v_mul_f32 v160, v160, v92
  v_mul_f32 v161, v161, v93
  v_cvt_pk_bf16_f32 v170, v160, v161
  v_mul_f32 v162, v94, v94
  v_mul_f32 v163, v95, v95
  v_fma_f32 v162, v162, v148, v149
  v_mfma_f32_32x32x16_bf16 v[96:111], a[244:247], v[132:135], v[96:111]
  s_mul_i32 s81, s81, 196608
  s_add_u32 m0, s68, 147456
  ds_read_b128 v[128:131], v38 offset:36864
  v_fma_f32 v163, v163, v148, v149
  v_mul_f32 v162, v162, v94
  v_mul_f32 v163, v163, v95
  v_exp_f32 v162, v162
  v_mfma_f32_32x32x16_bf16 v[96:111], a[248:251], v[136:139], v[96:111]
  buffer_load_dwordx4 v24, s[24:27], s81 offen lds
  ds_read_b128 v[132:135], v38 offset:37888
  v_exp_f32 v163, v163
  v_fma_f32 v162, v162, v150, v150
  v_fma_f32 v163, v163, v150, v150
  v_mfma_f32_32x32x16_bf16 v[96:111], a[252:255], v[140:143], v[96:111]
  buffer_load_dwordx4 v25, s[24:27], s81 offen offset:1024 lds
  ds_read_b128 v[136:139], v38 offset:38912
  v_rcp_f32 v162, v162
  v_rcp_f32 v163, v163
  s_waitcnt lgkmcnt(5)
  v_mfma_f32_32x32x16_bf16 v[96:111], v[68:71], v[144:147], v[96:111]
  v_mul_f32 v162, v162, v94
  v_mul_f32 v163, v163, v95
  v_cvt_pk_bf16_f32 v171, v162, v163
  buffer_store_dwordx4 v[164:167], v2, s[36:39], s72 offen offset:0 sc1
  buffer_store_dwordx4 v[168:171], v2, s[36:39], s72 offen offset:1024 sc1
  v_mfma_f32_32x32x16_bf16 v[80:95], a[0:3], v[112:115], 0
  s_waitcnt lgkmcnt(2)
  s_barrier
  ds_read_b128 v[140:143], v38 offset:39936
  v_mfma_f32_32x32x16_bf16 v[80:95], a[4:7], v[116:119], v[80:95]
  s_add_u32 s81, s81, 16384
  s_add_u32 m0, s68, 65536
  s_waitcnt vmcnt(18)
  ds_read_b128 v[112:115], v38 offset:40960
  ds_read_b64_tr_b16 v[172:173], v42 offset:0
  v_mul_f32 v156, v96, v96
  v_mul_f32 v157, v97, v97
  v_fma_f32 v156, v156, v152, v153
  v_mfma_f32_32x32x16_bf16 v[80:95], a[8:11], v[120:123], v[80:95]
  buffer_load_dwordx4 v24, s[24:27], s81 offen lds
  ds_read_b128 v[116:119], v38 offset:41984
  ds_read_b64_tr_b16 v[174:175], v42 offset:1024
  v_fma_f32 v157, v157, v152, v153
  v_mul_f32 v156, v156, v96
  v_mul_f32 v157, v157, v97
  v_mfma_f32_32x32x16_bf16 v[80:95], a[12:15], v[124:127], v[80:95]
  buffer_load_dwordx4 v25, s[24:27], s81 offen offset:1024 lds
  ds_read_b128 v[120:123], v38 offset:43008
  ds_read_b64_tr_b16 v[176:177], v43 offset:0
  ds_read_b64_tr_b16 v[178:179], v43 offset:1024
  v_exp_f32 v156, v156
  v_mfma_f32_32x32x16_bf16 v[80:95], a[16:19], v[128:131], v[80:95]
  s_waitcnt lgkmcnt(6)
  ds_read_b128 v[124:127], v38 offset:44032
  ds_read_b64_tr_b16 v[180:181], v42 offset:40960
  v_exp_f32 v157, v157
  v_fma_f32 v156, v156, v154, v154
  v_fma_f32 v157, v157, v154, v154
  v_rcp_f32 v156, v156
  v_mfma_f32_32x32x16_bf16 v[80:95], a[20:23], v[132:135], v[80:95]
  s_bfe_u32 s81, s64, 0x40018
  ds_read_b128 v[128:131], v38 offset:45056
  ds_read_b64_tr_b16 v[182:183], v42 offset:41984
  v_rcp_f32 v157, v157
  v_mul_f32 v156, v156, v96
  v_mul_f32 v157, v157, v97
  v_cvt_pk_bf16_f32 v72, v156, v157
  v_mfma_f32_32x32x16_bf16 v[80:95], a[24:27], v[136:139], v[80:95]
  s_mul_i32 s81, s81, 196608
  s_add_u32 m0, s68, 73728
  ds_read_b128 v[132:135], v38 offset:46080
  ds_read_b64_tr_b16 v[184:185], v43 offset:40960
  ds_read_b64_tr_b16 v[186:187], v43 offset:41984
  v_mul_f32 v158, v98, v98
  v_mul_f32 v159, v99, v99
  v_fma_f32 v158, v158, v152, v153
  v_mfma_f32_32x32x16_bf16 v[80:95], a[28:31], v[140:143], v[80:95]
  buffer_load_dwordx4 v24, s[24:27], s81 offen lds
  ds_read_b128 v[136:139], v38 offset:47104
  ds_read_b64_tr_b16 v[188:189], v42 offset:8192
  v_fma_f32 v159, v159, v152, v153
  v_mul_f32 v158, v158, v98
  v_mul_f32 v159, v159, v99
  v_mfma_f32_32x32x16_bf16 v[80:95], a[32:35], v[112:115], v[80:95]
  s_waitcnt lgkmcnt(6)
  ds_read_b128 v[140:143], v38 offset:48128
  ds_read_b64_tr_b16 v[190:191], v42 offset:9216
  ds_read_b64_tr_b16 v[192:193], v43 offset:8192
  v_exp_f32 v158, v158
  v_exp_f32 v159, v159
  v_mfma_f32_32x32x16_bf16 v[80:95], a[36:39], v[116:119], v[80:95]
  buffer_load_dwordx4 v25, s[24:27], s81 offen offset:1024 lds
  ds_read_b128 v[112:115], v38 offset:49152
  ds_read_b64_tr_b16 v[194:195], v43 offset:9216
  v_fma_f32 v158, v158, v154, v154
  v_fma_f32 v159, v159, v154, v154
  v_rcp_f32 v158, v158
  v_mfma_f32_32x32x16_bf16 v[80:95], a[40:43], v[120:123], v[80:95]
  s_add_u32 s81, s81, 16384
  ds_read_b128 v[116:119], v38 offset:50176
  ds_read_b128 v[20:23], v62 offset:32768
  v_rcp_f32 v159, v159
  v_mul_f32 v158, v158, v98
  v_mul_f32 v159, v159, v99
  v_cvt_pk_bf16_f32 v73, v158, v159
  v_mfma_f32_32x32x16_bf16 v[80:95], a[44:47], v[124:127], v[80:95]
  s_add_u32 m0, s68, 81920
  s_nop 0
  buffer_load_dwordx4 v24, s[24:27], s81 offen lds
  ds_read_b128 v[120:123], v38 offset:51200
  v_mul_f32 v160, v100, v100
  v_mul_f32 v161, v101, v101
  v_fma_f32 v160, v160, v152, v153
  v_mfma_f32_32x32x16_bf16 v[80:95], a[48:51], v[128:131], v[80:95]
  s_waitcnt lgkmcnt(4)
  ds_read_b128 v[124:127], v38 offset:52224
  v_fma_f32 v161, v161, v152, v153
  v_mul_f32 v160, v160, v100
  v_mul_f32 v161, v161, v101
  v_exp_f32 v160, v160
  v_exp_f32 v161, v161
  v_mfma_f32_32x32x16_bf16 v[80:95], a[52:55], v[132:135], v[80:95]
  buffer_load_dwordx4 v25, s[24:27], s81 offen offset:1024 lds
  ds_read_b128 v[128:131], v38 offset:53248
  v_fma_f32 v160, v160, v154, v154
  v_fma_f32 v161, v161, v154, v154
  v_rcp_f32 v160, v160
  v_mfma_f32_32x32x16_bf16 v[80:95], a[56:59], v[136:139], v[80:95]
  s_bfe_u32 s81, s66, 0x40000
  ds_read_b128 v[132:135], v38 offset:54272
  v_rcp_f32 v161, v161
  v_mul_f32 v160, v160, v100
  v_mul_f32 v161, v161, v101
  v_cvt_pk_bf16_f32 v74, v160, v161
  v_mul_f32 v162, v102, v102
  v_mfma_f32_32x32x16_bf16 v[80:95], a[60:63], v[140:143], v[80:95]
  s_mul_i32 s81, s81, 196608
  ds_read_b128 v[136:139], v38 offset:55296
  v_mul_f32 v163, v103, v103
  v_fma_f32 v162, v162, v152, v153
  v_fma_f32 v163, v163, v152, v153
  v_mul_f32 v162, v162, v102
  v_mul_f32 v163, v163, v103
  v_exp_f32 v162, v162
  v_mfma_f32_32x32x16_bf16 v[80:95], a[64:67], v[112:115], v[80:95]
  s_waitcnt lgkmcnt(2)
  ds_read_b128 v[140:143], v38 offset:56320
  v_exp_f32 v163, v163
  v_fma_f32 v162, v162, v154, v154
  v_fma_f32 v163, v163, v154, v154
  v_rcp_f32 v162, v162
  v_mfma_f32_32x32x16_bf16 v[80:95], a[68:71], v[116:119], v[80:95]
  s_add_u32 m0, s68, 90112
  s_nop 0
  buffer_load_dwordx4 v30, s[24:27], s81 offen lds
  ds_read_b128 v[112:115], v38 offset:57344
  v_rcp_f32 v163, v163
  v_mul_f32 v162, v162, v102
  v_mfma_f32_32x32x16_bf16 v[80:95], a[72:75], v[120:123], v[80:95]
  buffer_load_dwordx4 v31, s[24:27], s81 offen offset:1024 lds
  ds_read_b128 v[116:119], v38 offset:58368
  v_mul_f32 v163, v163, v103
  v_cvt_pk_bf16_f32 v75, v162, v163
  v_mul_f32 v156, v104, v104
  v_mul_f32 v157, v105, v105
  v_mfma_f32_32x32x16_bf16 v[80:95], a[76:79], v[124:127], v[80:95]
  ds_read_b128 v[120:123], v38 offset:59392
  v_fma_f32 v156, v156, v152, v153
  v_fma_f32 v157, v157, v152, v153
  v_mul_f32 v156, v156, v104
  v_mul_f32 v157, v157, v105
  v_exp_f32 v156, v156
  v_mfma_f32_32x32x16_bf16 v[80:95], a[80:83], v[128:131], v[80:95]
  s_waitcnt lgkmcnt(2)
  ds_read_b128 v[124:127], v38 offset:60416
  v_exp_f32 v157, v157
  v_fma_f32 v156, v156, v154, v154
  v_fma_f32 v157, v157, v154, v154
  v_rcp_f32 v156, v156
  v_mfma_f32_32x32x16_bf16 v[80:95], a[84:87], v[132:135], v[80:95]
  s_bfe_u32 s81, s66, 0x40004
  ds_read_b128 v[128:131], v38 offset:61440
  v_rcp_f32 v157, v157
  v_mul_f32 v156, v156, v104
  v_mul_f32 v157, v157, v105
  v_cvt_pk_bf16_f32 v76, v156, v157
L_pad5:
  s_cbranch_execz L_padback2
  v_mul_f32 v158, v106, v106
  v_mfma_f32_32x32x16_bf16 v[80:95], a[88:91], v[136:139], v[80:95]
  s_mul_i32 s81, s81, 196608
  s_add_u32 m0, s68, 0
  ds_read_b128 v[132:135], v38 offset:62464
  v_mul_f32 v159, v107, v107
  v_fma_f32 v158, v158, v152, v153
  v_fma_f32 v159, v159, v152, v153
  v_mul_f32 v158, v158, v106
  v_mul_f32 v159, v159, v107
  v_mfma_f32_32x32x16_bf16 v[80:95], a[92:95], v[140:143], v[80:95]
  buffer_load_dwordx4 v30, s[24:27], s81 offen lds
  ds_read_b128 v[136:139], v38 offset:63488
  v_exp_f32 v158, v158
  v_exp_f32 v159, v159
  v_mfma_f32_32x32x16_bf16 v[80:95], a[96:99], v[112:115], v[80:95]
  s_waitcnt lgkmcnt(2)
  ds_read_b128 v[140:143], v38 offset:64512
  v_fma_f32 v158, v158, v154, v154
  v_fma_f32 v159, v159, v154, v154
  v_rcp_f32 v158, v158
  v_rcp_f32 v159, v159
  v_mfma_f32_32x32x16_bf16 v[80:95], a[100:103], v[116:119], v[80:95]
  buffer_load_dwordx4 v31, s[24:27], s81 offen offset:1024 lds
  v_mul_f32 v158, v158, v106
  v_mul_f32 v159, v159, v107
  v_cvt_pk_bf16_f32 v77, v158, v159
  v_mul_f32 v160, v108, v108
  v_mul_f32 v161, v109, v109
  v_mfma_f32_32x32x16_bf16 v[80:95], a[104:107], v[120:123], v[80:95]
  v_fma_f32 v160, v160, v152, v153
  v_fma_f32 v161, v161, v152, v153
  v_mul_f32 v160, v160, v108
  v_mul_f32 v161, v161, v109
  v_exp_f32 v160, v160
  v_exp_f32 v161, v161
  v_mfma_f32_32x32x16_bf16 v[80:95], a[108:111], v[124:127], v[80:95]
  s_waitcnt vmcnt(10)
  s_add_u32 s3, s41, 2048
  s_mov_b64 exec, 65535
  buffer_store_dword v244, v13, s[36:39], s3 offen
  s_mov_b64 exec, -1
  s_bfe_u32 s81, s66, 0x40008
  s_mul_i32 s81, s81, 196608
  ds_read_b128 v[144:147], v41 offset:1024
  ds_read_b96 v[148:150], v41 offset:1040
  v_fma_f32 v160, v160, v154, v154
  v_mfma_f32_32x32x16_bf16 v[80:95], a[112:115], v[128:131], v[80:95]
  s_waitcnt lgkmcnt(2)
  v_fma_f32 v161, v161, v154, v154
  v_rcp_f32 v160, v160
  v_rcp_f32 v161, v161
  v_mul_f32 v160, v160, v108
  v_mul_f32 v161, v161, v109
  v_mfma_f32_32x32x16_bf16 v[80:95], a[116:119], v[132:135], v[80:95]
  s_add_u32 m0, s68, 40960
  v_cvt_pk_bf16_f32 v78, v160, v161
  v_mul_f32 v162, v110, v110
  v_mul_f32 v163, v111, v111
  v_fma_f32 v162, v162, v152, v153
  v_fma_f32 v163, v163, v152, v153
  v_mul_f32 v162, v162, v110
  v_mul_f32 v163, v163, v111
  v_mfma_f32_32x32x16_bf16 v[80:95], a[120:123], v[136:139], v[80:95]
  buffer_load_dwordx4 v30, s[24:27], s81 offen lds
  v_exp_f32 v162, v162
  v_exp_f32 v163, v163
  v_fma_f32 v162, v162, v154, v154
  v_mfma_f32_32x32x16_bf16 v[80:95], a[124:127], v[140:143], v[80:95]
  buffer_load_dwordx4 v31, s[24:27], s81 offen offset:1024 lds
  v_fma_f32 v163, v163, v154, v154
  v_rcp_f32 v162, v162
  v_rcp_f32 v163, v163
  s_waitcnt lgkmcnt(1)
  v_mfma_f32_32x32x16_bf16 v[80:95], v[64:67], v[144:147], v[80:95]
  v_mul_f32 v162, v162, v110
  v_mul_f32 v163, v163, v111
  v_cvt_pk_bf16_f32 v79, v162, v163
  buffer_store_dwordx4 v[72:75], v2, s[36:39], s73 offen offset:0 sc1
  buffer_store_dwordx4 v[76:79], v2, s[36:39], s74 offen offset:0 sc1
  s_barrier
  s_nop 5
  v_pk_mul_f32 v[156:157], v[80:81], v[80:81]
  v_pk_mul_f32 v[158:159], v[82:83], v[82:83]
  s_waitcnt lgkmcnt(0)
  v_pk_fma_f32 v[156:157], v[156:157], v[148:149], v[148:149] op_sel:[0,0,1] op_sel_hi:[1,0,1]
  v_pk_fma_f32 v[158:159], v[158:159], v[148:149], v[148:149] op_sel:[0,0,1] op_sel_hi:[1,0,1]
  v_pk_mul_f32 v[156:157], v[156:157], v[80:81]
  v_pk_mul_f32 v[158:159], v[158:159], v[82:83]
  v_exp_f32 v156, v156
  v_exp_f32 v158, v158
  v_exp_f32 v157, v157
  v_exp_f32 v159, v159
  v_pk_fma_f32 v[156:157], v[156:157], v[150:151], v[150:151] op_sel_hi:[1,0,0]
  v_pk_fma_f32 v[158:159], v[158:159], v[150:151], v[150:151] op_sel_hi:[1,0,0]
  v_rcp_f32 v156, v156
  v_rcp_f32 v158, v158
  v_rcp_f32 v157, v157
  v_rcp_f32 v159, v159
  v_pk_mul_f32 v[156:157], v[156:157], v[80:81]
  v_pk_mul_f32 v[158:159], v[158:159], v[82:83]
  v_cvt_pk_bf16_f32 v236, v156, v157
  v_cvt_pk_bf16_f32 v237, v158, v159
  v_pk_mul_f32 v[160:161], v[84:85], v[84:85]
  v_pk_mul_f32 v[162:163], v[86:87], v[86:87]
  v_pk_fma_f32 v[160:161], v[160:161], v[148:149], v[148:149] op_sel:[0,0,1] op_sel_hi:[1,0,1]
  v_pk_fma_f32 v[162:163], v[162:163], v[148:149], v[148:149] op_sel:[0,0,1] op_sel_hi:[1,0,1]
  v_pk_mul_f32 v[160:161], v[160:161], v[84:85]
  v_pk_mul_f32 v[162:163], v[162:163], v[86:87]
  v_exp_f32 v160, v160
  v_exp_f32 v162, v162
  v_exp_f32 v161, v161
  v_exp_f32 v163, v163
  v_pk_fma_f32 v[160:161], v[160:161], v[150:151], v[150:151] op_sel_hi:[1,0,0]
  v_pk_fma_f32 v[162:163], v[162:163], v[150:151], v[150:151] op_sel_hi:[1,0,0]
  v_rcp_f32 v160, v160
  v_rcp_f32 v162, v162
  v_rcp_f32 v161, v161
  v_rcp_f32 v163, v163
  v_pk_mul_f32 v[160:161], v[160:161], v[84:85]
  v_pk_mul_f32 v[162:163], v[162:163], v[86:87]
  v_cvt_pk_bf16_f32 v238, v160, v161
  v_cvt_pk_bf16_f32 v239, v162, v163
  v_pk_mul_f32 v[156:157], v[88:89], v[88:89]
  v_pk_mul_f32 v[158:159], v[90:91], v[90:91]
  v_pk_fma_f32 v[156:157], v[156:157], v[148:149], v[148:149] op_sel:[0,0,1] op_sel_hi:[1,0,1]
  v_pk_fma_f32 v[158:159], v[158:159], v[148:149], v[148:149] op_sel:[0,0,1] op_sel_hi:[1,0,1]
  v_pk_mul_f32 v[156:157], v[156:157], v[88:89]
  v_pk_mul_f32 v[158:159], v[158:159], v[90:91]
  v_exp_f32 v156, v156
  v_exp_f32 v158, v158
  v_exp_f32 v157, v157
  v_exp_f32 v159, v159
  v_pk_fma_f32 v[156:157], v[156:157], v[150:151], v[150:151] op_sel_hi:[1,0,0]
  v_pk_fma_f32 v[158:159], v[158:159], v[150:151], v[150:151] op_sel_hi:[1,0,0]
  v_rcp_f32 v156, v156
  v_rcp_f32 v158, v158
  v_rcp_f32 v157, v157
  v_rcp_f32 v159, v159
  v_pk_mul_f32 v[156:157], v[156:157], v[88:89]
  v_pk_mul_f32 v[158:159], v[158:159], v[90:91]
  v_cvt_pk_bf16_f32 v240, v156, v157
  v_cvt_pk_bf16_f32 v241, v158, v159
  v_pk_mul_f32 v[160:161], v[92:93], v[92:93]
  v_pk_mul_f32 v[162:163], v[94:95], v[94:95]
  v_pk_fma_f32 v[160:161], v[160:161], v[148:149], v[148:149] op_sel:[0,0,1] op_sel_hi:[1,0,1]
  v_pk_fma_f32 v[162:163], v[162:163], v[148:149], v[148:149] op_sel:[0,0,1] op_sel_hi:[1,0,1]
  v_pk_mul_f32 v[160:161], v[160:161], v[92:93]
  v_pk_mul_f32 v[162:163], v[162:163], v[94:95]
  v_exp_f32 v160, v160
  v_exp_f32 v162, v162
  v_exp_f32 v161, v161
  v_exp_f32 v163, v163
  s_add_u32 s71, s60, 2048
  s_load_dwordx8 s[84:91], s[36:37], s71
  v_pk_fma_f32 v[160:161], v[160:161], v[150:151], v[150:151] op_sel_hi:[1,0,0]
  v_pk_fma_f32 v[162:163], v[162:163], v[150:151], v[150:151] op_sel_hi:[1,0,0]
  v_rcp_f32 v160, v160
  v_rcp_f32 v162, v162
  v_rcp_f32 v161, v161
  v_rcp_f32 v163, v163
  v_pk_mul_f32 v[160:161], v[160:161], v[92:93]
  v_pk_mul_f32 v[162:163], v[162:163], v[94:95]
  v_cvt_pk_bf16_f32 v242, v160, v161
  v_cvt_pk_bf16_f32 v243, v162, v163
  buffer_store_dwordx4 v[236:239], v2, s[36:39], s58 offen offset:0 sc1
  buffer_store_dwordx4 v[240:243], v2, s[36:39], s58 offen offset:1024 sc1
  ds_read_b64_tr_b16 v[196:197], v42 offset:16384
  ds_read_b64_tr_b16 v[198:199], v42 offset:17408
  ds_read_b64_tr_b16 v[200:201], v43 offset:16384
  ds_read_b64_tr_b16 v[202:203], v43 offset:17408
  ds_read_b64_tr_b16 v[204:205], v42 offset:24576
  ds_read_b64_tr_b16 v[206:207], v42 offset:25600
  ds_read_b64_tr_b16 v[208:209], v43 offset:24576
  ds_read_b64_tr_b16 v[210:211], v43 offset:25600
  ds_read_b64_tr_b16 v[212:213], v42 offset:32768
  ds_read_b64_tr_b16 v[214:215], v42 offset:33792
  ds_read_b64_tr_b16 v[216:217], v43 offset:32768
  ds_read_b64_tr_b16 v[218:219], v43 offset:33792
  ds_read_b64_tr_b16 v[220:221], v42 offset:49152
  ds_read_b64_tr_b16 v[222:223], v42 offset:50176
  ds_read_b64_tr_b16 v[224:225], v43 offset:49152
  ds_read_b64_tr_b16 v[226:227], v43 offset:50176
  s_waitcnt vmcnt(2)
  s_add_u32 s3, s41, 4096
  s_mov_b64 exec, 65535
  buffer_store_dword v244, v13, s[36:39], s3 offen
  s_mov_b64 exec, -1
  s_bfe_u32 s81, s66, 0x4000c
  s_mul_i32 s81, s81, 196608
  s_add_u32 m0, s68, 8192
  s_nop 0
  buffer_load_dwordx4 v30, s[24:27], s81 offen lds
  v_lshlrev_b32 v80, 16, v16
  v_and_b32 v81, s80, v16
  v_lshlrev_b32 v156, 16, v250
  v_and_b32 v157, s80, v250
  v_pk_add_f32 v[80:81], v[80:81], v[156:157]
  v_lshlrev_b32 v82, 16, v17
  v_and_b32 v83, s80, v17
  v_lshlrev_b32 v156, 16, v251
  v_and_b32 v157, s80, v251
  v_pk_add_f32 v[82:83], v[82:83], v[156:157]
  v_lshlrev_b32 v84, 16, v18
  v_and_b32 v85, s80, v18
  buffer_load_dwordx4 v31, s[24:27], s81 offen offset:1024 lds
  v_lshlrev_b32 v156, 16, v252
  v_and_b32 v157, s80, v252
  v_pk_add_f32 v[84:85], v[84:85], v[156:157]
  v_lshlrev_b32 v86, 16, v19
  v_and_b32 v87, s80, v19
  v_lshlrev_b32 v156, 16, v253
  v_and_b32 v157, s80, v253
  v_pk_add_f32 v[86:87], v[86:87], v[156:157]
  v_mov_b64 v[88:89], 0
  v_mov_b64 v[90:91], 0
  v_mov_b64 v[92:93], 0
  v_mov_b64 v[94:95], 0
  s_waitcnt lgkmcnt(12)
  s_bfe_u32 s81, s66, 0x40010
  s_mul_i32 s81, s81, 196608
  s_add_u32 m0, s68, 16384
  s_nop 0
  buffer_load_dwordx4 v30, s[24:27], s81 offen lds
  v_lshlrev_b32 v112, 16, v20
  v_and_b32 v113, s80, v20
  v_lshlrev_b32 v156, 16, v250
  v_and_b32 v157, s80, v250
  v_pk_add_f32 v[112:113], v[112:113], v[156:157]
  v_lshlrev_b32 v114, 16, v21
  v_and_b32 v115, s80, v21
  v_lshlrev_b32 v156, 16, v251
  v_and_b32 v157, s80, v251
  v_pk_add_f32 v[114:115], v[114:115], v[156:157]
  v_lshlrev_b32 v116, 16, v22
  v_and_b32 v117, s80, v22
  buffer_load_dwordx4 v31, s[24:27], s81 offen offset:1024 lds
  v_lshlrev_b32 v156, 16, v252
  v_and_b32 v157, s80, v252
  v_pk_add_f32 v[116:117], v[116:117], v[156:157]
  v_lshlrev_b32 v118, 16, v23
  v_and_b32 v119, s80, v23
  v_lshlrev_b32 v156, 16, v253
  v_and_b32 v157, s80, v253
  v_pk_add_f32 v[118:119], v[118:119], v[156:157]
  v_mov_b64 v[120:121], 0
  v_mov_b64 v[122:123], 0
  v_mov_b64 v[124:125], 0
  v_mov_b64 v[126:127], 0
  v_mfma_f32_32x32x16_bf16 v[80:95], v[172:175], v[164:167], v[80:95]
  s_waitcnt lgkmcnt(8)
  s_bfe_u32 s81, s66, 0x40014
  s_mul_i32 s81, s81, 196608
  s_add_u32 m0, s68, 24576
  s_nop 0
  buffer_load_dwordx4 v30, s[24:27], s81 offen lds
  buffer_load_dwordx4 v31, s[24:27], s81 offen offset:1024 lds
  v_mfma_f32_32x32x16_bf16 v[96:111], v[176:179], v[164:167], 0
  s_waitcnt lgkmcnt(4)
  s_bfe_u32 s81, s66, 0x40018
  s_mul_i32 s81, s81, 196608
  s_add_u32 m0, s68, 32768
  s_nop 0
  buffer_load_dwordx4 v30, s[24:27], s81 offen lds
  buffer_load_dwordx4 v31, s[24:27], s81 offen offset:1024 lds
  v_mfma_f32_32x32x16_bf16 v[80:95], v[180:183], v[168:171], v[80:95]
  s_waitcnt lgkmcnt(0)
  s_bfe_u32 s81, s66, 0x4001c
  s_mul_i32 s81, s81, 196608
  s_add_u32 m0, s68, 49152
  s_nop 0
  buffer_load_dwordx4 v30, s[24:27], s81 offen lds
  buffer_load_dwordx4 v31, s[24:27], s81 offen offset:1024 lds
  v_mfma_f32_32x32x16_bf16 v[96:111], v[184:187], v[168:171], v[96:111]
  s_waitcnt lgkmcnt(0)
  s_xor_b64 s[84:85], s[84:85], s[0:1]
  s_xor_b64 s[86:87], s[86:87], s[0:1]
  s_xor_b64 s[88:89], s[88:89], s[0:1]
  s_xor_b64 s[90:91], s[90:91], s[0:1]
  s_or_b64 s[84:85], s[84:85], s[88:89]
  s_or_b64 s[86:87], s[86:87], s[90:91]
  s_or_b64 s[84:85], s[84:85], s[86:87]
  s_cbranch_scc1 L_pc24
L_pollo23:
  s_cmp_eq_u32 s44, 7
  s_cbranch_scc0 L_ar28
  s_add_u32 s49, s56, 147456
  buffer_load_dwordx4 a[240:243], v2, s[36:39], s49 offen offset:0 sc1
  buffer_load_dwordx4 a[244:247], v2, s[36:39], s49 offen offset:1024 sc1
L_ar28:
  s_add_u32 s52, s56, 147456
  s_bfe_u32 s49, s64, 0x40004
  s_lshl_b32 s49, s49, 11
  s_add_u32 s49, s49, s52
  buffer_load_dwordx4 a[0:3], v2, s[36:39], s49 offen offset:0 sc1
  v_mfma_f32_32x32x16_bf16 v[112:127], v[172:175], v[236:239], v[112:127]
  buffer_load_dwordx4 a[4:7], v2, s[36:39], s49 offen offset:1024 sc1
  s_bfe_u32 s49, s64, 0x40008
  s_lshl_b32 s49, s49, 11
  s_add_u32 s49, s49, s52
  buffer_load_dwordx4 a[8:11], v2, s[36:39], s49 offen offset:0 sc1
  v_mfma_f32_32x32x16_bf16 v[128:143], v[176:179], v[236:239], 0
  buffer_load_dwordx4 a[12:15], v2, s[36:39], s49 offen offset:1024 sc1
  s_bfe_u32 s49, s64, 0x4000c
  s_lshl_b32 s49, s49, 11
  s_add_u32 s49, s49, s52
  buffer_load_dwordx4 a[16:19], v2, s[36:39], s49 offen offset:0 sc1
  v_mfma_f32_32x32x16_bf16 v[112:127], v[180:183], v[240:243], v[112:127]
  buffer_load_dwordx4 a[20:23], v2, s[36:39], s49 offen offset:1024 sc1
  s_bfe_u32 s49, s64, 0x40010
  s_lshl_b32 s49, s49, 11
  s_add_u32 s49, s49, s52
  buffer_load_dwordx4 a[24:27], v2, s[36:39], s49 offen offset:0 sc1
  v_mfma_f32_32x32x16_bf16 v[128:143], v[184:187], v[240:243], v[128:143]
  buffer_load_dwordx4 a[28:31], v2, s[36:39], s49 offen offset:1024 sc1
  s_waitcnt vmcnt(19)
  s_add_u32 s3, s41, 6144
  s_mov_b64 exec, 65535
  buffer_store_dword v244, v13, s[36:39], s3 offen
  s_mov_b64 exec, -1
  s_bfe_u32 s49, s64, 0x40014
  s_lshl_b32 s49, s49, 11
  s_add_u32 s49, s49, s52
  buffer_load_dwordx4 a[32:35], v2, s[36:39], s49 offen offset:0 sc1
  s_add_u32 s71, s61, 4096
  s_load_dwordx16 s[84:99], s[36:37], s71
  buffer_load_dwordx4 a[36:39], v2, s[36:39], s49 offen offset:1024 sc1
  s_bfe_u32 s49, s64, 0x40018
  s_lshl_b32 s49, s49, 11
  s_add_u32 s49, s49, s52
  buffer_load_dwordx4 a[40:43], v2, s[36:39], s49 offen offset:0 sc1
  buffer_load_dwordx4 a[44:47], v2, s[36:39], s49 offen offset:1024 sc1
  s_waitcnt vmcnt(12)
  v_mfma_f32_32x32x16_bf16 v[80:95], v[188:191], a[0:3], v[80:95]
  s_waitcnt lgkmcnt(0)
  s_xor_b64 s[84:85], s[84:85], s[0:1]
  s_xor_b64 s[86:87], s[86:87], s[0:1]
  s_xor_b64 s[88:89], s[88:89], s[0:1]
  s_xor_b64 s[90:91], s[90:91], s[0:1]
  s_xor_b64 s[92:93], s[92:93], s[0:1]
  s_xor_b64 s[94:95], s[94:95], s[0:1]
  s_xor_b64 s[96:97], s[96:97], s[0:1]
  s_xor_b64 s[98:99], s[98:99], s[0:1]
  s_or_b64 s[84:85], s[84:85], s[92:93]
  s_or_b64 s[86:87], s[86:87], s[94:95]
  s_or_b64 s[88:89], s[88:89], s[96:97]
  s_or_b64 s[90:91], s[90:91], s[98:99]
  s_or_b64 s[84:85], s[84:85], s[88:89]
  s_or_b64 s[86:87], s[86:87], s[90:91]
  s_or_b64 s[84:85], s[84:85], s[86:87]
  s_cbranch_scc1 L_pc32
L_pollo31:
  s_add_u32 s52, s56, 212992
  s_bfe_u32 s49, s66, 0x40000
  s_lshl_b32 s49, s49, 11
  s_add_u32 s49, s49, s52
  ds_read_b64_tr_b16 v[228:229], v42 offset:57344
  ds_read_b64_tr_b16 v[230:231], v42 offset:58368
  v_mfma_f32_32x32x16_bf16 v[96:111], v[192:195], a[0:3], v[96:111]
  buffer_load_dwordx4 a[48:51], v2, s[36:39], s49 offen offset:0 sc1
  s_cmp_eq_u32 s44, 7
  s_cbranch_scc0 L_ar44
  v_mfma_f32_32x32x16_bf16 v[80:95], v[172:175], a[240:243], v[80:95]
  v_mfma_f32_32x32x16_bf16 v[96:111], v[176:179], a[240:243], v[96:111]
  v_mfma_f32_32x32x16_bf16 v[80:95], v[180:183], a[244:247], v[80:95]
  v_mfma_f32_32x32x16_bf16 v[96:111], v[184:187], a[244:247], v[96:111]
L_ar44:
  s_waitcnt vmcnt(12)
  ds_read_b64_tr_b16 v[232:233], v43 offset:57344
  ds_read_b64_tr_b16 v[234:235], v43 offset:58368
  v_mfma_f32_32x32x16_bf16 v[80:95], v[196:199], a[4:7], v[80:95]
  ds_read_b64_tr_b16 a[128:129], v44 offset:0
  ds_read_b64_tr_b16 a[130:131], v44 offset:1024
  v_mfma_f32_32x32x16_bf16 v[96:111], v[200:203], a[4:7], v[96:111]
  buffer_load_dwordx4 a[52:55], v2, s[36:39], s49 offen offset:1024 sc1
  s_waitcnt vmcnt(12)
  ds_read_b64_tr_b16 a[132:133], v45 offset:0
  ds_read_b64_tr_b16 a[134:135], v45 offset:1024
  v_mfma_f32_32x32x16_bf16 v[80:95], v[204:207], a[8:11], v[80:95]
  s_bfe_u32 s49, s66, 0x40004
  s_lshl_b32 s49, s49, 11
  s_add_u32 s49, s49, s52
  ds_read_b64_tr_b16 a[136:137], v44 offset:8192
  ds_read_b64_tr_b16 a[138:139], v44 offset:9216
  v_mfma_f32_32x32x16_bf16 v[96:111], v[208:211], a[8:11], v[96:111]
  buffer_load_dwordx4 a[56:59], v2, s[36:39], s49 offen offset:0 sc1
  s_waitcnt vmcnt(12)
  ds_read_b64_tr_b16 a[140:141], v45 offset:8192
  ds_read_b64_tr_b16 a[142:143], v45 offset:9216
  v_mfma_f32_32x32x16_bf16 v[80:95], v[212:215], a[12:15], v[80:95]
  ds_read_b64_tr_b16 a[144:145], v44 offset:16384
  ds_read_b64_tr_b16 a[146:147], v44 offset:17408
  v_mfma_f32_32x32x16_bf16 v[96:111], v[216:219], a[12:15], v[96:111]
  buffer_load_dwordx4 a[60:63], v2, s[36:39], s49 offen offset:1024 sc1
  s_waitcnt vmcnt(12)
  ds_read_b64_tr_b16 a[148:149], v45 offset:16384
  ds_read_b64_tr_b16 a[150:151], v45 offset:17408
  v_mfma_f32_32x32x16_bf16 v[80:95], v[220:223], a[16:19], v[80:95]
  s_bfe_u32 s49, s66, 0x40008
  s_lshl_b32 s49, s49, 11
  s_add_u32 s49, s49, s52
  ds_read_b64_tr_b16 a[152:153], v34 offset:0
  ds_read_b64_tr_b16 a[154:155], v34 offset:1024
  v_mfma_f32_32x32x16_bf16 v[96:111], v[224:227], a[16:19], v[96:111]
  buffer_load_dwordx4 a[64:67], v2, s[36:39], s49 offen offset:0 sc1
  s_waitcnt vmcnt(12)
  ds_read_b64_tr_b16 a[156:157], v35 offset:0
  ds_read_b64_tr_b16 a[158:159], v35 offset:1024
  s_waitcnt lgkmcnt(14)
  v_mfma_f32_32x32x16_bf16 v[80:95], v[228:231], a[20:23], v[80:95]
  ds_read_b64_tr_b16 a[160:161], v34 offset:8192
  ds_read_b64_tr_b16 a[162:163], v34 offset:9216
  v_mfma_f32_32x32x16_bf16 v[96:111], v[232:235], a[20:23], v[96:111]
  buffer_load_dwordx4 a[68:71], v2, s[36:39], s49 offen offset:1024 sc1
  s_waitcnt vmcnt(12)
  ds_read_b64_tr_b16 a[164:165], v35 offset:8192
  ds_read_b64_tr_b16 a[166:167], v35 offset:9216
  v_mfma_f32_32x32x16_bf16 v[80:95], a[128:131], a[24:27], v[80:95]
  s_bfe_u32 s49, s66, 0x4000c
  s_lshl_b32 s49, s49, 11
  s_add_u32 s49, s49, s52
  ds_read_b64_tr_b16 a[168:169], v34 offset:16384
  ds_read_b64_tr_b16 a[170:171], v34 offset:17408
  s_waitcnt lgkmcnt(14)
  v_mfma_f32_32x32x16_bf16 v[96:111], a[132:135], a[24:27], v[96:111]
  buffer_load_dwordx4 a[72:75], v2, s[36:39], s49 offen offset:0 sc1
  s_waitcnt vmcnt(12)
  ds_read_b64_tr_b16 a[172:173], v35 offset:16384
  ds_read_b64_tr_b16 a[174:175], v35 offset:17408
  v_mfma_f32_32x32x16_bf16 v[80:95], a[136:139], a[28:31], v[80:95]
  ds_read_b64_tr_b16 a[176:177], v34 offset:24576
  ds_read_b64_tr_b16 a[178:179], v34 offset:25600
  v_mfma_f32_32x32x16_bf16 v[96:111], a[140:143], a[28:31], v[96:111]
  buffer_load_dwordx4 a[76:79], v2, s[36:39], s49 offen offset:1024 sc1
  s_waitcnt vmcnt(11)
  ds_read_b64_tr_b16 a[180:181], v35 offset:24576
  ds_read_b64_tr_b16 a[182:183], v35 offset:25600
  s_waitcnt lgkmcnt(14)
  v_mfma_f32_32x32x16_bf16 v[80:95], a[144:147], a[32:35], v[80:95]
  s_bfe_u32 s49, s66, 0x40010
  s_lshl_b32 s49, s49, 11
  s_add_u32 s49, s49, s52
  ds_read_b64_tr_b16 a[184:185], v42 offset:0
  ds_read_b64_tr_b16 a[186:187], v42 offset:1024
  v_mfma_f32_32x32x16_bf16 v[96:111], a[148:151], a[32:35], v[96:111]
  buffer_load_dwordx4 a[80:83], v2, s[36:39], s49 offen offset:0 sc1
  s_waitcnt vmcnt(11)
  ds_read_b64_tr_b16 a[188:189], v43 offset:0
  ds_read_b64_tr_b16 a[190:191], v43 offset:1024
  v_mfma_f32_32x32x16_bf16 v[80:95], a[152:155], a[36:39], v[80:95]
  ds_read_b64_tr_b16 a[192:193], v42 offset:40960
  ds_read_b64_tr_b16 a[194:195], v42 offset:41984
  s_waitcnt lgkmcnt(14)
  v_mfma_f32_32x32x16_bf16 v[96:111], a[156:159], a[36:39], v[96:111]
  buffer_load_dwordx4 a[84:87], v2, s[36:39], s49 offen offset:1024 sc1
  s_waitcnt vmcnt(11)
  ds_read_b64_tr_b16 a[196:197], v43 offset:40960
  ds_read_b64_tr_b16 a[198:199], v43 offset:41984
  v_mfma_f32_32x32x16_bf16 v[80:95], a[160:163], a[40:43], v[80:95]
  s_bfe_u32 s49, s66, 0x40014
  s_lshl_b32 s49, s49, 11
  s_add_u32 s49, s49, s52
  ds_read_b64_tr_b16 a[200:201], v42 offset:8192
  ds_read_b64_tr_b16 a[202:203], v42 offset:9216
  v_mfma_f32_32x32x16_bf16 v[96:111], a[164:167], a[40:43], v[96:111]
  buffer_load_dwordx4 a[88:91], v2, s[36:39], s49 offen offset:0 sc1
  s_waitcnt vmcnt(11)
  ds_read_b64_tr_b16 a[204:205], v43 offset:8192
  ds_read_b64_tr_b16 a[206:207], v43 offset:9216
  s_waitcnt lgkmcnt(14)
  v_mfma_f32_32x32x16_bf16 v[80:95], a[168:171], a[44:47], v[80:95]
  ds_read_b64_tr_b16 a[208:209], v42 offset:16384
  ds_read_b64_tr_b16 a[210:211], v42 offset:17408
  v_mfma_f32_32x32x16_bf16 v[96:111], a[172:175], a[44:47], v[96:111]
  buffer_load_dwordx4 a[92:95], v2, s[36:39], s49 offen offset:1024 sc1
  s_waitcnt vmcnt(11)
  ds_read_b64_tr_b16 a[212:213], v43 offset:16384
  ds_read_b64_tr_b16 a[214:215], v43 offset:17408
  v_mfma_f32_32x32x16_bf16 v[80:95], a[176:179], a[48:51], v[80:95]
  s_bfe_u32 s49, s66, 0x40018
  s_lshl_b32 s49, s49, 11
  s_add_u32 s49, s49, s52
  ds_read_b64_tr_b16 a[216:217], v42 offset:24576
  ds_read_b64_tr_b16 a[218:219], v42 offset:25600
  s_waitcnt lgkmcnt(14)
  v_mfma_f32_32x32x16_bf16 v[96:111], a[180:183], a[48:51], v[96:111]
  buffer_load_dwordx4 a[96:99], v2, s[36:39], s49 offen offset:0 sc1
  s_waitcnt vmcnt(11)
  ds_read_b64_tr_b16 a[220:221], v43 offset:24576
  ds_read_b64_tr_b16 a[222:223], v43 offset:25600
  v_mfma_f32_32x32x16_bf16 v[112:127], a[176:179], a[52:55], v[112:127]
  s_add_u32 s71, s60, 6144
  s_load_dwordx8 s[84:91], s[36:37], s71
  s_bfe_u32 s49, s66, 0x4001c
  s_lshl_b32 s49, s49, 11
  s_add_u32 s49, s49, s52
  ds_read_b64_tr_b16 a[224:225], v42 offset:32768
  ds_read_b64_tr_b16 a[226:227], v42 offset:33792
  v_mfma_f32_32x32x16_bf16 v[128:143], a[180:183], a[52:55], v[128:143]
  buffer_load_dwordx4 a[100:103], v2, s[36:39], s49 offen offset:0 sc1
  s_waitcnt vmcnt(11)
  ds_read_b64_tr_b16 a[228:229], v43 offset:32768
  ds_read_b64_tr_b16 a[230:231], v43 offset:33792
  v_mfma_f32_32x32x16_bf16 v[80:95], a[184:187], a[56:59], v[80:95]
  s_bfe_u32 s49, s66, 0x40018
  s_lshl_b32 s49, s49, 11
  s_add_u32 s49, s49, s52
  ds_read_b64_tr_b16 a[232:233], v42 offset:49152
  ds_read_b64_tr_b16 a[234:235], v42 offset:50176
  v_mfma_f32_32x32x16_bf16 v[96:111], a[188:191], a[56:59], v[96:111]
  buffer_load_dwordx4 a[104:107], v2, s[36:39], s49 offen offset:1024 sc1
  s_waitcnt vmcnt(11)
  ds_read_b64_tr_b16 a[236:237], v43 offset:49152
  ds_read_b64_tr_b16 a[238:239], v43 offset:50176
  v_mfma_f32_32x32x16_bf16 v[112:127], a[184:187], a[60:63], v[112:127]
  s_bfe_u32 s49, s66, 0x4001c
  s_lshl_b32 s49, s49, 11
  s_add_u32 s49, s49, s52
  s_mul_i32 s51, s46, 10304
  s_add_u32 s51, s51, 65536
  v_mfma_f32_32x32x16_bf16 v[128:143], a[188:191], a[60:63], v[128:143]
  buffer_load_dwordx4 a[108:111], v2, s[36:39], s49 offen offset:1024 sc1
  s_waitcnt vmcnt(11)
  v_xor_b32 v144, s51, v2
  v_xor_b32 v145, 1056, v144
  s_waitcnt lgkmcnt(0)
  v_mfma_f32_32x32x16_bf16 v[80:95], a[192:195], a[64:67], v[80:95]
  s_waitcnt lgkmcnt(0)
  s_xor_b64 s[84:85], s[84:85], s[0:1]
  s_xor_b64 s[86:87], s[86:87], s[0:1]
  s_xor_b64 s[88:89], s[88:89], s[0:1]
  s_xor_b64 s[90:91], s[90:91], s[0:1]
  s_or_b64 s[84:85], s[84:85], s[88:89]
  s_or_b64 s[86:87], s[86:87], s[90:91]
  s_or_b64 s[84:85], s[84:85], s[86:87]
  s_cbranch_scc1 L_pc38
L_pollo37:
  s_cmp_eq_u32 s44, 7
  s_cbranch_scc0 L_ar42
  s_add_u32 s49, s56, 278528
  buffer_load_dwordx4 a[240:243], v2, s[36:39], s49 offen offset:0 sc1
  buffer_load_dwordx4 a[244:247], v2, s[36:39], s49 offen offset:1024 sc1
L_ar42:
  s_add_u32 s52, s56, 278528
  s_bfe_u32 s49, s64, 0x40004
  s_lshl_b32 s49, s49, 11
  s_add_u32 s49, s49, s52
  v_xor_b32 v146, 2112, v144
  v_xor_b32 v147, 3168, v144
  v_mfma_f32_32x32x16_bf16 v[96:111], a[196:199], a[64:67], v[96:111]
  buffer_load_dwordx4 a[112:115], v2, s[36:39], s49 offen offset:0 sc1
  s_waitcnt vmcnt(11)
  v_xor_b32 v148, 4224, v144
  v_mfma_f32_32x32x16_bf16 v[112:127], a[192:195], a[68:71], v[112:127]
  v_xor_b32 v149, 5280, v144
  v_xor_b32 v150, 6336, v144
  v_mfma_f32_32x32x16_bf16 v[128:143], a[196:199], a[68:71], v[128:143]
  buffer_load_dwordx4 a[116:119], v2, s[36:39], s49 offen offset:1024 sc1
  s_waitcnt vmcnt(11)
  v_xor_b32 v151, 7392, v144
  v_and_b32 v153, 7, v1
  v_mfma_f32_32x32x16_bf16 v[80:95], a[200:203], a[72:75], v[80:95]
  s_bfe_u32 s49, s64, 0x40008
  s_lshl_b32 s49, s49, 11
  s_add_u32 s49, s49, s52
  v_lshrrev_b32 v154, 3, v1
  s_lshl_b32 s51, s46, 3
  v_mfma_f32_32x32x16_bf16 v[96:111], a[204:207], a[72:75], v[96:111]
  buffer_load_dwordx4 a[120:123], v2, s[36:39], s49 offen offset:0 sc1
  s_waitcnt vmcnt(11)
  v_add_u32 v154, s51, v154
  v_mfma_f32_32x32x16_bf16 v[112:127], a[200:203], a[76:79], v[112:127]
  v_mul_u32_u24 v152, 1056, v153
  v_lshlrev_b32 v155, 4, v154
  v_mfma_f32_32x32x16_bf16 v[128:143], a[204:207], a[76:79], v[128:143]
  buffer_load_dwordx4 a[124:127], v2, s[36:39], s49 offen offset:1024 sc1
  s_waitcnt vmcnt(11)
  v_xor_b32 v152, v152, v155
  v_add_u32 v152, 65536, v152
  v_mfma_f32_32x32x16_bf16 v[80:95], a[208:211], a[80:83], v[80:95]
  s_bfe_u32 s49, s64, 0x4000c
  s_lshl_b32 s49, s49, 11
  s_add_u32 s49, s49, s52
  s_lshl_b32 s51, s44, 7
  v_lshl_add_u32 v153, v153, 4, s51
  v_mfma_f32_32x32x16_bf16 v[96:111], a[212:215], a[80:83], v[96:111]
  buffer_load_dwordx4 a[0:3], v2, s[36:39], s49 offen offset:0 sc1
  s_waitcnt vmcnt(11)
  v_lshl_add_u32 v153, v154, 10, v153
  v_mfma_f32_32x32x16_bf16 v[112:127], a[208:211], a[84:87], v[112:127]
  v_mfma_f32_32x32x16_bf16 v[128:143], a[212:215], a[84:87], v[128:143]
  buffer_load_dwordx4 a[4:7], v2, s[36:39], s49 offen offset:1024 sc1
  s_waitcnt vmcnt(11)
  v_mfma_f32_32x32x16_bf16 v[80:95], a[216:219], a[88:91], v[80:95]
  s_bfe_u32 s49, s64, 0x40010
  s_lshl_b32 s49, s49, 11
  s_add_u32 s49, s49, s52
  v_mfma_f32_32x32x16_bf16 v[96:111], a[220:223], a[88:91], v[96:111]
  buffer_load_dwordx4 a[8:11], v2, s[36:39], s49 offen offset:0 sc1
  s_waitcnt vmcnt(11)
  v_mfma_f32_32x32x16_bf16 v[112:127], a[216:219], a[92:95], v[112:127]
  v_mfma_f32_32x32x16_bf16 v[128:143], a[220:223], a[92:95], v[128:143]
  buffer_load_dwordx4 a[12:15], v2, s[36:39], s49 offen offset:1024 sc1
  s_waitcnt vmcnt(11)
  v_mfma_f32_32x32x16_bf16 v[80:95], a[224:227], a[96:99], v[80:95]
  s_bfe_u32 s49, s64, 0x40014
  s_lshl_b32 s49, s49, 11
  s_add_u32 s49, s49, s52
  v_mfma_f32_32x32x16_bf16 v[96:111], a[228:231], a[96:99], v[96:111]
  buffer_load_dwordx4 a[16:19], v2, s[36:39], s49 offen offset:0 sc1
  s_waitcnt vmcnt(11)
  v_mfma_f32_32x32x16_bf16 v[80:95], a[232:235], a[100:103], v[80:95]
  v_mfma_f32_32x32x16_bf16 v[96:111], a[236:239], a[100:103], v[96:111]
  buffer_load_dwordx4 a[20:23], v2, s[36:39], s49 offen offset:1024 sc1
  s_waitcnt vmcnt(11)
  v_mfma_f32_32x32x16_bf16 v[112:127], a[224:227], a[104:107], v[112:127]
  s_bfe_u32 s49, s64, 0x40018
  s_lshl_b32 s49, s49, 11
  s_add_u32 s49, s49, s52
  v_mfma_f32_32x32x16_bf16 v[128:143], a[228:231], a[104:107], v[128:143]
  buffer_load_dwordx4 a[24:27], v2, s[36:39], s49 offen offset:0 sc1
  s_waitcnt vmcnt(11)
  v_mfma_f32_32x32x16_bf16 v[112:127], a[232:235], a[108:111], v[112:127]
  v_mfma_f32_32x32x16_bf16 v[128:143], a[236:239], a[108:111], v[128:143]
  buffer_load_dwordx4 a[28:31], v2, s[36:39], s49 offen offset:1024 sc1
  s_waitcnt vmcnt(11)
  ds_write_b128 v144, v[80:83] offset:32768
  v_mfma_f32_32x32x16_bf16 v[112:127], v[188:191], a[112:115], v[112:127]
  ds_write_b128 v145, v[84:87] offset:32768
  v_mfma_f32_32x32x16_bf16 v[128:143], v[192:195], a[112:115], v[128:143]
  s_cmp_eq_u32 s44, 7
  s_cbranch_scc0 L_ar46
  v_mfma_f32_32x32x16_bf16 v[112:127], v[172:175], a[240:243], v[112:127]
  v_mfma_f32_32x32x16_bf16 v[128:143], v[176:179], a[240:243], v[128:143]
  v_mfma_f32_32x32x16_bf16 v[112:127], v[180:183], a[244:247], v[112:127]
  v_mfma_f32_32x32x16_bf16 v[128:143], v[184:187], a[244:247], v[128:143]
L_ar46:
  s_waitcnt vmcnt(10)
  ds_write_b128 v146, v[88:91] offset:32768
  v_mfma_f32_32x32x16_bf16 v[112:127], v[196:199], a[116:119], v[112:127]
  ds_write_b128 v147, v[92:95] offset:32768
  v_mfma_f32_32x32x16_bf16 v[128:143], v[200:203], a[116:119], v[128:143]
  s_waitcnt vmcnt(9)
  ds_write_b128 v148, v[96:99] offset:32768
  v_mfma_f32_32x32x16_bf16 v[112:127], v[204:207], a[120:123], v[112:127]
  ds_write_b128 v149, v[100:103] offset:32768
  v_mfma_f32_32x32x16_bf16 v[128:143], v[208:211], a[120:123], v[128:143]
  s_waitcnt vmcnt(8)
  ds_write_b128 v150, v[104:107] offset:32768
  v_mfma_f32_32x32x16_bf16 v[112:127], v[212:215], a[124:127], v[112:127]
L_pad6:
  s_cbranch_execz L_padback2
  ds_write_b128 v151, v[108:111] offset:32768
  v_mfma_f32_32x32x16_bf16 v[128:143], v[216:219], a[124:127], v[128:143]
  s_waitcnt vmcnt(7)
  v_mfma_f32_32x32x16_bf16 v[112:127], v[220:223], a[0:3], v[112:127]
  s_mov_b64 exec, 28
  buffer_store_dword v12, v246, s[36:39], s40 offen sc1
  s_mov_b64 exec, -1
  s_waitcnt lgkmcnt(0)
  s_barrier
  ds_read_b128 v[80:83], v152 offset:32768
  ds_read_b128 v[84:87], v152 offset:33280
  v_mfma_f32_32x32x16_bf16 v[128:143], v[224:227], a[0:3], v[128:143]
  s_waitcnt vmcnt(7)
  ds_read_b128 v[88:91], v152 offset:40960
  ds_read_b128 v[92:95], v152 offset:41472
  v_mfma_f32_32x32x16_bf16 v[112:127], v[228:231], a[4:7], v[112:127]
  ds_read_b128 v[96:99], v152 offset:49152
  ds_read_b128 v[100:103], v152 offset:49664
  v_mfma_f32_32x32x16_bf16 v[128:143], v[232:235], a[4:7], v[128:143]
  s_waitcnt vmcnt(6)
  ds_read_b128 v[104:107], v152 offset:57344
  ds_read_b128 v[108:111], v152 offset:57856
  v_mfma_f32_32x32x16_bf16 v[112:127], a[128:131], a[8:11], v[112:127]
  v_mfma_f32_32x32x16_bf16 v[128:143], a[132:135], a[8:11], v[128:143]
  s_waitcnt vmcnt(5)
  s_waitcnt lgkmcnt(5)
  v_add_f32 v80, v80, v88
  v_add_f32 v81, v81, v89
  v_add_f32 v82, v82, v90
  v_add_f32 v83, v83, v91
  s_waitcnt lgkmcnt(4)
  v_add_f32 v84, v84, v92
  v_mfma_f32_32x32x16_bf16 v[128:143], a[140:143], a[12:15], v[128:143]
  s_waitcnt vmcnt(4)
  v_add_f32 v85, v85, v93
  v_add_f32 v86, v86, v94
  v_add_f32 v87, v87, v95
  s_waitcnt lgkmcnt(1)
  v_add_f32 v96, v96, v104
  v_add_f32 v97, v97, v105
  v_add_f32 v98, v98, v106
  v_add_f32 v99, v99, v107
  s_waitcnt lgkmcnt(0)
  v_add_f32 v100, v100, v108
  v_add_f32 v101, v101, v109
  v_add_f32 v102, v102, v110
  v_mfma_f32_32x32x16_bf16 v[128:143], a[148:151], a[16:19], v[128:143]
  s_waitcnt vmcnt(3)
  v_add_f32 v103, v103, v111
  v_add_f32 v80, v80, v96
  v_add_f32 v81, v81, v97
  v_add_f32 v82, v82, v98
  v_add_f32 v83, v83, v99
  v_add_f32 v84, v84, v100
  v_add_f32 v85, v85, v101
  v_add_f32 v86, v86, v102
  v_add_f32 v87, v87, v103
  v_cvt_pk_bf16_f32 v160, v80, v81
  v_mfma_f32_32x32x16_bf16 v[128:143], a[156:159], a[20:23], v[128:143]
  s_waitcnt vmcnt(2)
  v_cvt_pk_bf16_f32 v161, v82, v83
  v_cvt_pk_bf16_f32 v162, v84, v85
  v_cvt_pk_bf16_f32 v163, v86, v87
  s_add_u32 s51, s53, 0
  buffer_store_dwordx4 v[160:163], v153, s[32:35], s51 offen sc1
  v_mfma_f32_32x32x16_bf16 v[128:143], a[164:167], a[24:27], v[128:143]
  s_waitcnt vmcnt(2)
  v_mfma_f32_32x32x16_bf16 v[128:143], a[172:175], a[28:31], v[128:143]
  v_mfma_f32_32x32x16_bf16 v[112:127], a[136:139], a[12:15], v[112:127]
  v_mfma_f32_32x32x16_bf16 v[112:127], a[144:147], a[16:19], v[112:127]
  s_nop 9
  ds_write_b128 v148, v[128:131] offset:0
  v_mfma_f32_32x32x16_bf16 v[112:127], a[152:155], a[20:23], v[112:127]
  ds_write_b128 v149, v[132:135] offset:0
  v_mfma_f32_32x32x16_bf16 v[112:127], a[160:163], a[24:27], v[112:127]
  ds_write_b128 v150, v[136:139] offset:0
  v_mfma_f32_32x32x16_bf16 v[112:127], a[168:171], a[28:31], v[112:127]
  ds_write_b128 v151, v[140:143] offset:0
  s_nop 10
  ds_write_b128 v144, v[112:115] offset:0
  ds_write_b128 v145, v[116:119] offset:0
  ds_write_b128 v146, v[120:123] offset:0
  ds_write_b128 v147, v[124:127] offset:0
  s_waitcnt lgkmcnt(0)
  s_barrier
  ds_read_b128 v[112:115], v152 offset:0
  ds_read_b128 v[116:119], v152 offset:512
  ds_read_b128 v[120:123], v152 offset:8192
  ds_read_b128 v[124:127], v152 offset:8704
  ds_read_b128 v[128:131], v152 offset:16384
  ds_read_b128 v[132:135], v152 offset:16896
  ds_read_b128 v[136:139], v152 offset:24576
  ds_read_b128 v[140:143], v152 offset:25088
  s_waitcnt lgkmcnt(5)
  v_pk_add_f32 v[112:113], v[112:113], v[120:121]
  v_pk_add_f32 v[114:115], v[114:115], v[122:123]
  s_waitcnt lgkmcnt(4)
  v_pk_add_f32 v[116:117], v[116:117], v[124:125]
  v_pk_add_f32 v[118:119], v[118:119], v[126:127]
  s_waitcnt lgkmcnt(1)
  v_pk_add_f32 v[128:129], v[128:129], v[136:137]
  v_pk_add_f32 v[130:131], v[130:131], v[138:139]
  s_waitcnt lgkmcnt(0)
  v_pk_add_f32 v[132:133], v[132:133], v[140:141]
  v_pk_add_f32 v[134:135], v[134:135], v[142:143]
  v_pk_add_f32 v[112:113], v[112:113], v[128:129]
  v_pk_add_f32 v[114:115], v[114:115], v[130:131]
  v_pk_add_f32 v[116:117], v[116:117], v[132:133]
  v_pk_add_f32 v[118:119], v[118:119], v[134:135]
  v_cvt_pk_bf16_f32 v160, v112, v113
  v_cvt_pk_bf16_f32 v161, v114, v115
  v_cvt_pk_bf16_f32 v162, v116, v117
  v_cvt_pk_bf16_f32 v163, v118, v119
  s_add_u32 s51, s53, 32768
  buffer_store_dwordx4 v[160:163], v153, s[32:35], s51 offen
L_end:
  s_endpgm
  s_nop 0
L_padw:
  s_branch L_padback
L_pc24:
  s_mov_b32 s55, 1
L_sp21:
  s_add_u32 s71, s71, 64
  s_load_dwordx8 s[84:91], s[36:37], s71
  s_add_u32 s55, s55, 1
  s_waitcnt lgkmcnt(0)
  s_xor_b64 s[84:85], s[84:85], s[0:1]
  s_xor_b64 s[86:87], s[86:87], s[0:1]
  s_xor_b64 s[88:89], s[88:89], s[0:1]
  s_xor_b64 s[90:91], s[90:91], s[0:1]
  s_or_b64 s[84:85], s[84:85], s[88:89]
  s_or_b64 s[86:87], s[86:87], s[90:91]
  s_or_b64 s[84:85], s[84:85], s[86:87]
  s_cbranch_scc0 L_pollo23
  s_cmp_lt_u32 s55, 16
  s_cbranch_scc1 L_sp21
  s_branch L_pc24x
L_pc32:
  s_mov_b32 s55, 1
L_sp29:
  s_add_u32 s71, s71, 64
  s_load_dwordx16 s[84:99], s[36:37], s71
  s_add_u32 s55, s55, 1
  s_waitcnt lgkmcnt(0)
  s_xor_b64 s[84:85], s[84:85], s[0:1]
  s_xor_b64 s[86:87], s[86:87], s[0:1]
  s_xor_b64 s[88:89], s[88:89], s[0:1]
  s_xor_b64 s[90:91], s[90:91], s[0:1]
  s_xor_b64 s[92:93], s[92:93], s[0:1]
  s_xor_b64 s[94:95], s[94:95], s[0:1]
  s_xor_b64 s[96:97], s[96:97], s[0:1]
  s_xor_b64 s[98:99], s[98:99], s[0:1]
  s_or_b64 s[84:85], s[84:85], s[92:93]
  s_or_b64 s[86:87], s[86:87], s[94:95]
  s_or_b64 s[88:89], s[88:89], s[96:97]
  s_or_b64 s[90:91], s[90:91], s[98:99]
  s_or_b64 s[84:85], s[84:85], s[88:89]
  s_or_b64 s[86:87], s[86:87], s[90:91]
  s_or_b64 s[84:85], s[84:85], s[86:87]
  s_cbranch_scc0 L_pollo31
  s_cmp_lt_u32 s55, 16
  s_cbranch_scc1 L_sp29
  s_branch L_pc32x
L_pc38:
  s_mov_b32 s55, 1
L_sp35:
  s_add_u32 s71, s71, 64
  s_load_dwordx8 s[84:91], s[36:37], s71
  s_add_u32 s55, s55, 1
  s_waitcnt lgkmcnt(0)
  s_xor_b64 s[84:85], s[84:85], s[0:1]
  s_xor_b64 s[86:87], s[86:87], s[0:1]
  s_xor_b64 s[88:89], s[88:89], s[0:1]
  s_xor_b64 s[90:91], s[90:91], s[0:1]
  s_or_b64 s[84:85], s[84:85], s[88:89]
  s_or_b64 s[86:87], s[86:87], s[90:91]
  s_or_b64 s[84:85], s[84:85], s[86:87]
  s_cbranch_scc0 L_pollo37
  s_cmp_lt_u32 s55, 16
  s_cbranch_scc1 L_sp35
  s_branch L_pc38x
L_pc8:
  s_waitcnt lgkmcnt(0)
  s_mov_b32 s100, 0
  s_mov_b64 exec, 1
  buffer_store_dword v12, v246, s[36:39], s40 offen sc1
  s_mov_b64 exec, -1
L_poll6:
  s_bitcmp1_b32 s55, 0
  s_cbranch_scc1 L_pq9
  v_and_b32 v15, 7, v1
  v_lshlrev_b32 v15, 2, v15
  s_add_u32 s71, s40, 0
  s_mov_b32 s101, s0
  s_branch L_pd10
L_pq9:
  v_and_b32 v15, 7, v1
  v_lshlrev_b32 v15, 9, v15
  s_mul_i32 s71, s46, 0
  s_add_u32 s71, s71, s40
  s_add_u32 s71, s71, 8192
  s_mov_b32 s101, s42
L_pd10:
  buffer_load_dword v14, v15, s[36:39], s71 offen sc1
  s_add_u32 s55, s55, 1
  s_waitcnt vmcnt(0)
  v_cmp_ne_u32 vcc, s101, v14
  s_cmp_lt_u32 s55, 0x40000
  s_cbranch_vccz L_pollo7
  s_cbranch_scc1 L_poll6
  s_branch L_pollo7
L_gp11:
  buffer_load_dwordx4 v[128:131], v2, s[36:39], s72 offen offset:0 sc1
  buffer_load_dwordx4 v[132:135], v2, s[36:39], s72 offen offset:1024 sc1
  buffer_load_dwordx4 v[136:139], v2, s[36:39], s72 offen offset:2048 sc1
  buffer_load_dwordx4 v[140:143], v2, s[36:39], s72 offen offset:3072 sc1
  buffer_load_dwordx4 v[144:147], v2, s[36:39], s73 offen offset:0 sc1
  buffer_load_dwordx4 v[148:151], v2, s[36:39], s73 offen offset:1024 sc1
  buffer_load_dwordx4 v[152:155], v2, s[36:39], s73 offen offset:2048 sc1
  buffer_load_dwordx4 v[156:159], v2, s[36:39], s73 offen offset:3072 sc1
  buffer_load_dwordx4 v[160:163], v40, s[36:39], s74 offen sc1
  s_add_u32 s55, s55, 1
  s_waitcnt vmcnt(0)
  v_xor_b32 v164, v129, v12
  v_mov_b32 v129, v130
  ds_write_b64 v38, v[128:129] offset:0
  v_bitop3_b32 v164, v164, v131, v12 bitop3:0xf6
  v_bitop3_b32 v164, v164, v133, v12 bitop3:0xf6
  v_mov_b32 v133, v134
  ds_write_b64 v38, v[132:133] offset:544
  v_bitop3_b32 v164, v164, v135, v12 bitop3:0xf6
  v_bitop3_b32 v164, v164, v137, v12 bitop3:0xf6
  v_mov_b32 v137, v138
  ds_write_b64 v38, v[136:137] offset:1088
  v_bitop3_b32 v164, v164, v139, v12 bitop3:0xf6
  v_bitop3_b32 v164, v164, v141, v12 bitop3:0xf6
  v_mov_b32 v141, v142
  ds_write_b64 v38, v[140:141] offset:1632
  v_bitop3_b32 v164, v164, v143, v12 bitop3:0xf6
  v_bitop3_b32 v164, v164, v145, v12 bitop3:0xf6
  v_mov_b32 v145, v146
  ds_write_b64 v38, v[144:145] offset:2176
  v_bitop3_b32 v164, v164, v147, v12 bitop3:0xf6
  v_bitop3_b32 v164, v164, v149, v12 bitop3:0xf6
  v_mov_b32 v149, v150
  ds_write_b64 v38, v[148:149] offset:2720
  v_bitop3_b32 v164, v164, v151, v12 bitop3:0xf6
  v_bitop3_b32 v164, v164, v153, v12 bitop3:0xf6
  v_mov_b32 v153, v154
  ds_write_b64 v38, v[152:153] offset:3264
  v_bitop3_b32 v164, v164, v155, v12 bitop3:0xf6
  v_bitop3_b32 v164, v164, v157, v12 bitop3:0xf6
  v_mov_b32 v157, v158
  ds_write_b64 v38, v[156:157] offset:3808
  v_bitop3_b32 v164, v164, v159, v12 bitop3:0xf6
  v_bitop3_b32 v164, v164, v161, v12 bitop3:0xf6
  v_mov_b32 v161, v162
  ds_write_b64 v39, v[160:161] offset:512
  v_bitop3_b32 v164, v164, v163, v12 bitop3:0xf6
  v_cmp_ne_u32 vcc, 0, v164
  s_waitcnt lgkmcnt(0)
  s_cmp_gt_u32 s55, 0x40000
  s_cbranch_scc1 L_gpo12
  s_cbranch_vccnz L_gp11
  s_branch L_gpo12
L_pc18:
  s_waitcnt lgkmcnt(0)
  s_mov_b32 s100, 0
  s_mov_b64 exec, 3
  buffer_store_dword v12, v246, s[36:39], s40 offen sc1
  s_mov_b64 exec, -1
L_poll16:
  s_bitcmp1_b32 s55, 0
  s_cbranch_scc1 L_pq19
  v_and_b32 v15, 7, v1
  v_lshlrev_b32 v15, 2, v15
  s_add_u32 s71, s40, 1024
  s_mov_b32 s101, s0
  s_branch L_pd20
L_pq19:
  v_and_b32 v15, 7, v1
  v_lshlrev_b32 v15, 9, v15
  s_mul_i32 s71, s46, 0
  s_add_u32 s71, s71, s40
  s_add_u32 s71, s71, 8196
  s_mov_b32 s101, s42
L_pd20:
  buffer_load_dword v14, v15, s[36:39], s71 offen sc1
  s_add_u32 s55, s55, 1
  s_waitcnt vmcnt(0)
  v_cmp_ne_u32 vcc, s101, v14
  s_cmp_lt_u32 s55, 0x40000
  s_cbranch_vccz L_pollo17
  s_cbranch_scc1 L_poll16
  s_branch L_pollo17
L_pc24x:
  s_mov_b32 s100, 0
  s_mov_b64 exec, 15
  buffer_store_dword v12, v246, s[36:39], s40 offen sc1
  s_mov_b64 exec, -1
L_poll22:
  s_bitcmp1_b32 s55, 0
  s_cbranch_scc1 L_pq25
  v_and_b32 v15, 7, v1
  v_lshlrev_b32 v15, 2, v15
  s_add_u32 s71, s60, 2048
  s_mov_b32 s101, s0
  s_branch L_pd26
L_pq25:
  v_and_b32 v15, 7, v1
  v_lshlrev_b32 v15, 9, v15
  s_mul_i32 s71, s46, 128
  s_add_u32 s71, s71, s40
  s_add_u32 s71, s71, 8200
  s_mov_b32 s101, s42
L_pd26:
  buffer_load_dword v14, v15, s[36:39], s71 offen sc1
  s_add_u32 s55, s55, 1
  s_waitcnt vmcnt(0)
  v_cmp_ne_u32 vcc, s101, v14
  s_cmp_lt_u32 s55, 0x40000
  s_cbranch_vccz L_pollo23
  s_cbranch_scc1 L_poll22
  s_branch L_pollo23
L_pc32x:
  s_mov_b32 s100, 0
  s_mov_b64 exec, 31
  buffer_store_dword v12, v246, s[36:39], s40 offen sc1
  s_mov_b64 exec, -1
L_poll30:
  s_bitcmp1_b32 s55, 0
  s_cbranch_scc1 L_pq33
  v_and_b32 v15, 15, v1
  v_lshlrev_b32 v15, 2, v15
  s_add_u32 s71, s61, 4096
  s_mov_b32 s101, s0
  s_branch L_pd34
L_pq33:
  v_and_b32 v15, 7, v1
  v_lshlrev_b32 v15, 9, v15
  v_and_b32 v14, 8, v1
  v_lshl_add_u32 v15, v14, 4, v15
  s_lshl_b32 s71, s48, 8
  s_add_u32 s71, s71, s40
  s_add_u32 s71, s71, 8204
  s_mov_b32 s101, s42
L_pd34:
  buffer_load_dword v14, v15, s[36:39], s71 offen sc1
  s_add_u32 s55, s55, 1
  s_waitcnt vmcnt(0)
  v_cmp_ne_u32 vcc, s101, v14
  s_cmp_lt_u32 s55, 0x40000
  s_cbranch_vccz L_pollo31
  s_cbranch_scc1 L_poll30
  s_branch L_pollo31
L_pc38x:
  s_mov_b32 s100, 0
  s_mov_b64 exec, 31
  buffer_store_dword v12, v246, s[36:39], s40 offen sc1
  s_mov_b64 exec, -1
L_poll36:
  s_bitcmp1_b32 s55, 0
  s_cbranch_scc1 L_pq39
  v_and_b32 v15, 7, v1
  v_lshlrev_b32 v15, 2, v15
  s_add_u32 s71, s60, 6144
  s_mov_b32 s101, s0
  s_branch L_pd40
L_pq39:
  v_and_b32 v15, 7, v1
  v_lshlrev_b32 v15, 9, v15
  s_mul_i32 s71, s46, 128
  s_add_u32 s71, s71, s40
  s_add_u32 s71, s71, 8208
  s_mov_b32 s101, s42
L_pd40:
  buffer_load_dword v14, v15, s[36:39], s71 offen sc1
  s_add_u32 s55, s55, 1
  s_waitcnt vmcnt(0)
  v_cmp_ne_u32 vcc, s101, v14
  s_cmp_lt_u32 s55, 0x40000
  s_cbranch_vccz L_pollo37
  s_cbranch_scc1 L_poll36
  s_branch L_pollo37
L_code_end:
.section .rodata,"a"
.p2align 6
.amdhsa_kernel sequential_preLN__linear_attn_block__dense_activation_gelu__prompt_kernel
  .amdhsa_next_free_vgpr 512
  .amdhsa_next_free_sgpr 102
  .amdhsa_accum_offset 256
  .amdhsa_group_segment_fixed_size 0
  .amdhsa_kernarg_size 88
  .amdhsa_user_sgpr_count 2
  .amdhsa_user_sgpr_kernarg_segment_ptr 1
  .amdhsa_system_sgpr_workgroup_id_x 1
  .amdhsa_float_denorm_mode_32 3
.end_amdhsa_kernel
```
